```python
import torch

def _softmax(x, axis=-1):
    return torch.softmax(x, dim=axis)
def _gelu(x):
    return torch.nn.functional.gelu(x, approximate="tanh")
def _silu(x):
    return torch.nn.functional.silu(x)
def _sigmoid(x):
    return torch.sigmoid(x)
def _layernorm(x, axis=-1, eps=1e-5):
    m = x.mean(dim=axis, keepdim=True)
    v = x.var(dim=axis, keepdim=True, unbiased=False)
    return (x - m) / torch.sqrt(v + eps)
def _scatter_add(tgt, idx, src, axis=0):
    return tgt.clone().index_add_(axis, idx, src)
def _segment_sum(src, seg, n):
    out = torch.zeros((n,) + src.shape[1:], dtype=src.dtype)
    return out.index_add_(0, seg, src)
def _pad(x, pw):
    flat = tuple(v for pair in reversed(pw) for v in pair)
    return torch.nn.functional.pad(x, flat)

kernel_name = 'recurrent_scan__gqa_block_cached__glu_gated_glu__decode'

def setup_inputs():

    _w = (lambda a: (lambda t: t.to(torch.bfloat16) if t.is_floating_point() else t)(torch.as_tensor(a)))
    def _A_setup():
        B, Sq, D = 8, 1, 512
        Hq, Hkv, Sk, Dh = 32, 8, 4096, 128
        assert Hq % Hkv == 0, (Hq, Hkv)
        return {
            "x": _w((lambda *s: torch.randn(*s, dtype=torch.bfloat16) * 0.05)(B, Sq, D)),
            "k_cache": _w((lambda *s: torch.randn(*s, dtype=torch.bfloat16) * 1.6)(B, Hkv, Sk, Dh)),
            "v_cache": _w((lambda *s: torch.randn(*s, dtype=torch.bfloat16) * 0.2)(B, Hkv, Sk, Dh)),
            "wq": _w((lambda *s: torch.randn(*s, dtype=torch.bfloat16) * 1.6)(D, Hq * Dh) * (D ** -0.5)),
            "wo": _w((lambda *s: torch.randn(*s, dtype=torch.bfloat16) * 0.2)(Hq * Dh, D) * ((Hq * Dh) ** -0.5)),
        }
    _A_in = _A_setup()

    def _B_setup():
        B, S, D, F = 8, 1, 512, 1792
        return {
            "x": _w((lambda *s: torch.randn(*s, dtype=torch.bfloat16) * 0.05)(B, S, D)),
            "w_gate": _w((lambda *s: torch.randn(*s, dtype=torch.bfloat16) * 1.6)(D, F)),
            "w_up": _w((lambda *s: torch.randn(*s, dtype=torch.bfloat16) * 0.1)(D, F)),
            "w_down": _w((lambda *s: torch.randn(*s, dtype=torch.bfloat16) * 0.1)(F, D)),
        }
    _B_in = _B_setup()

    return {
        "A_x": _A_in["x"],
        "A_k_cache": _A_in["k_cache"],
        "A_v_cache": _A_in["v_cache"],
        "A_wq": _A_in["wq"],
        "A_wo": _A_in["wo"],
        "B_x": _B_in["x"],
        "B_w_gate": _B_in["w_gate"],
        "B_w_up": _B_in["w_up"],
        "B_w_down": _B_in["w_down"],
    }

def reference(A_x, A_k_cache, A_v_cache, A_wq, A_wo, B_x, B_w_gate, B_w_up, B_w_down):
    def _A_ref(x, k_cache, v_cache, wq, wo):
        B, Sq, D = x.shape
        Hq, Dh = 32, 128
        Hkv = k_cache.shape[1]
        rep = Hq // Hkv
        q = (lambda x, *d: x.permute(*d))((x @ wq).reshape(B, Sq, Hq, Dh), 0, 2, 1, 3)
        k = (lambda x, n, axis: torch.repeat_interleave(x, n, dim=axis))(k_cache, rep, axis=1)
        v = (lambda x, n, axis: torch.repeat_interleave(x, n, dim=axis))(v_cache, rep, axis=1)
        scores = torch.einsum("bhqd,bhkd->bhqk", q, k) * (Dh ** -0.5)
        p = _softmax(scores, axis=-1)
        o = torch.einsum("bhqk,bhkd->bhqd", p, v)
        return (lambda x, *d: x.permute(*d))(o, 0, 2, 1, 3).reshape(B, Sq, Hq * Dh) @ wo

    def _B_ref(x, w_gate, w_up, w_down):
        g = torch.einsum("bsd,df->bsf", x, w_gate)
        u = torch.einsum("bsd,df->bsf", x, w_up)
        h = _sigmoid(g) * u
        return torch.einsum("bsf,fd->bsd", h, w_down)

    x = A_x
    xn = _layernorm(x, axis=-1)
    s = _A_ref(xn, A_k_cache, A_v_cache, A_wq, A_wo)
    g = _silu(_B_ref(xn, B_w_gate, B_w_up, B_w_down))
    return x + s * g
```

```asm
; @launch grid=(256,1,1) block=(512,1,1) lds=161536
.amdgcn_target "amdgcn-amd-amdhsa--gfx950"
.text
.globl recurrent_scan__gqa_block_cached__glu_gated_glu__decode_kernel
.p2align 8
.type recurrent_scan__gqa_block_cached__glu_gated_glu__decode_kernel,@function
recurrent_scan__gqa_block_cached__glu_gated_glu__decode_kernel:
  s_cmp_ge_u32 s2, 256
  s_cbranch_scc1 L_end
  s_load_dwordx2 s[8:9], s[0:1], 0
  s_load_dwordx2 s[52:53], s[0:1], 8
  s_load_dwordx2 s[12:13], s[0:1], 24
  s_load_dwordx2 s[16:17], s[0:1], 88
  s_load_dwordx2 s[60:61], s[0:1], 16
  s_load_dwordx4 s[56:59], s[0:1], 48
  v_lshrrev_b32 v1, 6, v0
  v_and_b32 v0, 63, v0
  v_readfirstlane_b32 s3, v1
  s_and_b32 s4, s2, 7
  s_lshr_b32 s5, s2, 3
  s_cmp_ge_u32 s3, 4
  s_cbranch_scc0 L_S
  v_lshlrev_b32 v6, 2, v0
  v_add_u32 v6, 157184, v6
  v_mov_b32 v7, 0
  ds_write_b32 v6, v7
  s_sub_u32 s7, s3, 4
  s_mov_b32 s10, 8192
  s_mov_b32 s11, 0x20000
  v_lshrrev_b32 v6, 5, v0
  s_lshl_b32 s20, s7, 1
  v_add_u32 v6, s20, v6
  v_and_b32 v7, 31, v0
  v_lshlrev_b32 v7, 5, v7
  v_lshl_add_u32 v8, v6, 10, v7
  s_waitcnt lgkmcnt(0)
  buffer_load_dwordx4 v[16:19], v8, s[8:11], 0 offen
  buffer_load_dwordx4 v[20:23], v8, s[8:11], 0 offen offset:16
  v_lshrrev_b32 v9, 3, v0
  v_and_b32 v10, 7, v0
  v_lshlrev_b32 v10, 4, v10
  v_lshl_add_u32 v11, v9, 13, v10
  s_and_b32 s52, s5, 3
  s_lshr_b32 s51, s5, 2
  s_lshl_b32 s20, s52, 2
  s_add_u32 s20, s20, s7
  s_lshl_b32 s20, s20, 18
  s_lshl_b32 s21, s4, 3
  s_add_u32 s21, s21, s51
  s_lshl_b32 s21, s21, 7
  s_add_u32 s20, s20, s21
  s_lshr_b32 s21, s7, 1
  s_lshl_b32 s21, s21, 15
  s_and_b32 s22, s7, 1
  s_lshl_b32 s22, s22, 12
  s_add_u32 s21, s21, s22
  s_add_u32 s21, s21, 24576
  s_mov_b32 s14, 0x400000
  s_mov_b32 s15, 0x20000
  s_add_u32 m0, s21, 0
  s_load_dword s28, s[16:17], 0xff000
  buffer_load_dwordx4 v11, s[12:15], s20 offen nt lds
  s_add_u32 m0, s21, 1024
  s_add_u32 s20, s20, 65536
  buffer_load_dwordx4 v11, s[12:15], s20 offen nt lds
  s_add_u32 m0, s21, 2048
  s_add_u32 s20, s20, 65536
  buffer_load_dwordx4 v11, s[12:15], s20 offen nt lds
  s_add_u32 m0, s21, 3072
  s_add_u32 s20, s20, 65536
  buffer_load_dwordx4 v11, s[12:15], s20 offen nt lds
  s_barrier
  s_branch L_H2
L_S:
  s_cmp_lg_u32 s3, 3
  s_cbranch_scc1 Lpf_1
  s_and_b32 s20, s5, 15
  s_cmp_lg_u32 s20, 0
  s_cbranch_scc1 Lpf_1
  s_getpc_b64 s[22:23]
L_pc:
  v_lshlrev_b32 v30, 7, v0
  v_add_u32 v31, 0x2000, v30
  global_load_dword v72, v30, s[22:23]
  v_cmp_gt_u32 vcc, L_code_end-L_pc, v31
  s_and_saveexec_b64 s[24:25], vcc
  s_cbranch_execz L_pf_done
  global_load_dword v73, v31, s[22:23]
L_pf_done:
  s_mov_b64 exec, -1
Lpf_1:
  s_mov_b32 s54, 0x4000000
  s_mov_b32 s55, 0x20000
  s_lshr_b32 s20, s5, 2
  s_lshl_b32 s20, s20, 3
  s_add_u32 s20, s20, s4
  s_lshl_b32 s20, s20, 2
  s_and_b32 s21, s5, 3
  s_add_u32 s20, s20, s21
  s_lshl_b32 s20, s20, 18
  s_lshl_b32 s21, s3, 13
  s_add_u32 s28, s20, s21
  s_add_u32 s49, s28, 4096
  s_lshl_b32 s30, s3, 15
  s_mov_b32 s31, 0
  v_lshrrev_b32 v28, 4, v0
  v_and_b32 v29, 15, v0
  v_add_u32 v30, 0, v28
  v_xor_b32 v30, v30, v29
  v_lshlrev_b32 v30, 4, v30
  v_lshl_add_u32 v12, v28, 8, v30
  v_add_u32 v30, 4, v28
  v_xor_b32 v30, v30, v29
  v_lshlrev_b32 v30, 4, v30
  v_lshl_add_u32 v13, v28, 8, v30
  v_add_u32 v30, 8, v28
  v_xor_b32 v30, v30, v29
  v_lshlrev_b32 v30, 4, v30
  v_lshl_add_u32 v14, v28, 8, v30
  v_add_u32 v30, 12, v28
  v_xor_b32 v30, v30, v29
  v_lshlrev_b32 v30, 4, v30
  v_lshl_add_u32 v15, v28, 8, v30
  v_mov_b32 v2, 157184
  v_mov_b32 v3, 1
  s_waitcnt lgkmcnt(0)
  s_barrier
L_fill:
  s_cmp_lg_u32 s31, 3
  s_cbranch_scc1 L_fill_go
  s_mov_b32 s6, 0
Lw_2:
  ds_read_b32 v33, v2 offset:20
  s_waitcnt lgkmcnt(0)
  v_readfirstlane_b32 s27, v33
  s_cmp_ge_u32 s27, 4
  s_cbranch_scc1 Lwd_3
  s_add_u32 s6, s6, 1
  s_cmp_lt_u32 s6, 4000000
  s_cbranch_scc0 Lwd_3
  s_sleep 1
  s_branch Lw_2
Lwd_3:
L_fill_go:
  s_add_u32 s20, s31, s5
  s_and_b32 s20, s20, 7
  s_lshl_b32 s20, s20, 15
  s_add_u32 s32, s20, s28
  s_add_u32 s50, s20, s49
  s_and_b32 s20, s31, 3
  s_lshl_b32 s20, s20, 13
  s_add_u32 m0, s20, s30
  s_add_u32 s31, s31, 1
  s_waitcnt vmcnt(7)
  buffer_load_dwordx4 v12, s[52:55], s32 offen offset:0 nt lds
  s_waitcnt vmcnt(7)
  buffer_load_dwordx4 v13, s[52:55], s32 offen offset:1024 nt lds
  s_waitcnt vmcnt(7)
  buffer_load_dwordx4 v14, s[52:55], s32 offen offset:2048 nt lds
  s_waitcnt vmcnt(7)
  buffer_load_dwordx4 v15, s[52:55], s32 offen offset:3072 nt lds
  s_add_u32 m0, m0, 4096
  s_waitcnt vmcnt(7)
  buffer_load_dwordx4 v12, s[52:55], s50 offen offset:0 nt lds
  s_waitcnt vmcnt(7)
  buffer_load_dwordx4 v13, s[52:55], s50 offen offset:1024 nt lds
  s_waitcnt vmcnt(7)
  buffer_load_dwordx4 v14, s[52:55], s50 offen offset:2048 nt lds
  s_waitcnt vmcnt(7)
  buffer_load_dwordx4 v15, s[52:55], s50 offen offset:3072 nt lds
  s_cmp_lt_u32 s31, 4
  s_cbranch_scc1 L_fill
  s_load_dword s48, s[16:17], 0xff000
  s_mov_b32 s62, 0x4000000
  s_mov_b32 s63, 0x20000
  s_mov_b32 s18, 0x10000000
  s_mov_b32 s19, 0x20000
  v_add_u32 v30, 0, v28
  v_lshlrev_b32 v30, 1, v30
  v_xor_b32 v30, v30, v29
  v_lshlrev_b32 v30, 4, v30
  v_lshl_add_u32 v8, v28, 8, v30
  v_add_u32 v30, 4, v28
  v_lshlrev_b32 v30, 1, v30
  v_xor_b32 v30, v30, v29
  v_lshlrev_b32 v30, 4, v30
  v_lshl_add_u32 v9, v28, 8, v30
  v_add_u32 v30, 0, v28
  v_xor_b32 v30, v30, v29
  v_lshlrev_b32 v30, 4, v30
  v_lshl_add_u32 v30, v29, 8, v30
  v_add_u32 v16, s30, v30
  v_add_u32 v30, 4, v28
  v_xor_b32 v30, v30, v29
  v_lshlrev_b32 v30, 4, v30
  v_lshl_add_u32 v30, v29, 8, v30
  v_add_u32 v17, s30, v30
  v_add_u32 v30, 8, v28
  v_xor_b32 v30, v30, v29
  v_lshlrev_b32 v30, 4, v30
  v_lshl_add_u32 v30, v29, 8, v30
  v_add_u32 v18, s30, v30
  v_add_u32 v30, 12, v28
  v_xor_b32 v30, v30, v29
  v_lshlrev_b32 v30, 4, v30
  v_lshl_add_u32 v30, v29, 8, v30
  v_add_u32 v19, s30, v30
  v_lshrrev_b32 v30, 2, v29
  v_lshl_add_u32 v30, v28, 2, v30
  v_and_b32 v31, 7, v30
  v_lshlrev_b32 v30, 8, v30
  v_and_b32 v32, 3, v29
  v_lshl_add_u32 v30, v32, 3, v30
  v_add_u32 v30, s30, v30
  v_xor_b32 v32, 0, v31
  v_lshl_add_u32 v20, v32, 5, v30
  v_xor_b32 v32, 1, v31
  v_lshl_add_u32 v21, v32, 5, v30
  v_xor_b32 v32, 2, v31
  v_lshl_add_u32 v22, v32, 5, v30
  v_xor_b32 v32, 3, v31
  v_lshl_add_u32 v23, v32, 5, v30
  v_xor_b32 v32, 4, v31
  v_lshl_add_u32 v24, v32, 5, v30
  v_xor_b32 v32, 5, v31
  v_lshl_add_u32 v25, v32, 5, v30
  v_xor_b32 v32, 6, v31
  v_lshl_add_u32 v26, v32, 5, v30
  v_xor_b32 v32, 7, v31
  v_lshl_add_u32 v27, v32, 5, v30
  v_mov_b32 v136, 0
  v_mov_b32 v137, 0
  v_mov_b32 v138, 0
  v_mov_b32 v139, 0
  v_mov_b32 v140, 0
  v_mov_b32 v141, 0
  v_mov_b32 v142, 0
  v_mov_b32 v143, 0
  v_mov_b32 v144, 0
  v_mov_b32 v145, 0
  v_mov_b32 v146, 0
  v_mov_b32 v147, 0
  v_mov_b32 v148, 0
  v_mov_b32 v149, 0
  v_mov_b32 v150, 0
  v_mov_b32 v151, 0
  v_mov_b32 v152, 0
  v_mov_b32 v153, 0
  v_mov_b32 v154, 0
  v_mov_b32 v155, 0
  v_mov_b32 v156, 0
  v_mov_b32 v157, 0
  v_mov_b32 v158, 0
  v_mov_b32 v159, 0
  v_mov_b32 v160, 0
  v_mov_b32 v161, 0
  v_mov_b32 v162, 0
  v_mov_b32 v163, 0
  v_mov_b32 v164, 0
  v_mov_b32 v165, 0
  v_mov_b32 v166, 0
  v_mov_b32 v167, 0
  v_mov_b32 v168, 0
  v_mov_b32 v169, 0
  v_mov_b32 v170, 0
  v_mov_b32 v171, 0
  v_mov_b32 v172, 0
  v_mov_b32 v173, 0
  v_mov_b32 v174, 0
  v_mov_b32 v175, 0
  v_mov_b32 v176, 0
  v_mov_b32 v177, 0
  v_mov_b32 v178, 0
  v_mov_b32 v179, 0
  v_mov_b32 v180, 0
  v_mov_b32 v181, 0
  v_mov_b32 v182, 0
  v_mov_b32 v183, 0
  v_mov_b32 v184, 0
  v_mov_b32 v185, 0
  v_mov_b32 v186, 0
  v_mov_b32 v187, 0
  v_mov_b32 v188, 0
  v_mov_b32 v189, 0
  v_mov_b32 v190, 0
  v_mov_b32 v191, 0
  v_mov_b32 v192, 0
  v_mov_b32 v193, 0
  v_mov_b32 v194, 0
  v_mov_b32 v195, 0
  v_mov_b32 v196, 0
  v_mov_b32 v197, 0
  v_mov_b32 v198, 0
  v_mov_b32 v199, 0
  v_bfe_u32 v30, v0, 2, 2
  v_cmp_eq_u32 s[34:35], 0, v30
  v_cmp_eq_u32 s[36:37], 1, v30
  v_cmp_eq_u32 s[38:39], 2, v30
  v_cmp_eq_u32 s[40:41], 3, v30
  v_and_b32 v30, 3, v0
  v_mul_u32_u24 v30, 272, v30
  v_lshl_add_u32 v30, v28, 4, v30
  v_add_u32 v30, 139520, v30
  s_mov_b32 s42, 0x3DB504F3
  s_mov_b32 s43, 0xffff0000
  s_mov_b32 s6, 0
Lw_4:
  ds_read_b32 v33, v2 offset:16
  s_waitcnt lgkmcnt(0)
  v_readfirstlane_b32 s27, v33
  s_cmp_ge_u32 s27, 4
  s_cbranch_scc1 Lwd_5
  s_add_u32 s6, s6, 1
  s_cmp_lt_u32 s6, 4000000
  s_cbranch_scc0 Lwd_5
  s_sleep 1
  s_branch Lw_4
Lwd_5:
  s_mov_b64 exec, s[34:35]
  ds_read_b128 v[136:139], v30 offset:0
  ds_read_b128 v[140:143], v30 offset:64
  ds_read_b128 v[144:147], v30 offset:128
  ds_read_b128 v[148:151], v30 offset:192
  s_mov_b64 exec, s[36:37]
  ds_read_b128 v[152:155], v30 offset:0
  ds_read_b128 v[156:159], v30 offset:64
  ds_read_b128 v[160:163], v30 offset:128
  ds_read_b128 v[164:167], v30 offset:192
  s_mov_b64 exec, s[38:39]
  ds_read_b128 v[168:171], v30 offset:0
  ds_read_b128 v[172:175], v30 offset:64
  ds_read_b128 v[176:179], v30 offset:128
  ds_read_b128 v[180:183], v30 offset:192
  s_mov_b64 exec, s[40:41]
  ds_read_b128 v[184:187], v30 offset:0
  ds_read_b128 v[188:191], v30 offset:64
  ds_read_b128 v[192:195], v30 offset:128
  ds_read_b128 v[196:199], v30 offset:192
  s_mov_b64 exec, -1
  s_mov_b32 s33, 0
  s_waitcnt vmcnt(0) lgkmcnt(0)
L_k:
  s_cmp_lg_u32 s3, 0
  s_cbranch_scc1 Lmid_6
  s_cmp_lg_u32 s33, 2
  s_cbranch_scc1 Lmid_6
  s_mov_b64 exec, 1
  ds_add_u32 v2, v3 offset:60
  s_mov_b64 exec, -1
Lmid_6:
  s_cmp_lt_u32 s33, 3
  s_cbranch_scc1 Lsk_7
  s_add_u32 s20, s31, s5
  s_and_b32 s20, s20, 7
  s_lshl_b32 s20, s20, 15
  s_add_u32 s32, s20, s28
  s_add_u32 s50, s20, s49
  s_and_b32 s20, s31, 3
  s_lshl_b32 s20, s20, 13
  s_add_u32 m0, s20, s30
  s_add_u32 s31, s31, 1
  s_waitcnt vmcnt(7)
  buffer_load_dwordx4 v12, s[52:55], s32 offen offset:0 nt lds
  s_waitcnt vmcnt(7)
  buffer_load_dwordx4 v13, s[52:55], s32 offen offset:1024 nt lds
  s_waitcnt vmcnt(7)
  buffer_load_dwordx4 v14, s[52:55], s32 offen offset:2048 nt lds
  s_waitcnt vmcnt(7)
  buffer_load_dwordx4 v15, s[52:55], s32 offen offset:3072 nt lds
  s_add_u32 m0, m0, 4096
  s_waitcnt vmcnt(7)
  buffer_load_dwordx4 v12, s[52:55], s50 offen offset:0 nt lds
  s_waitcnt vmcnt(7)
  buffer_load_dwordx4 v13, s[52:55], s50 offen offset:1024 nt lds
  s_waitcnt vmcnt(7)
  buffer_load_dwordx4 v14, s[52:55], s50 offen offset:2048 nt lds
  s_waitcnt vmcnt(7)
  buffer_load_dwordx4 v15, s[52:55], s50 offen offset:3072 nt lds
Lsk_7:
  ds_read_b128 v[72:75], v16 offset:0
  ds_read_b128 v[76:79], v17 offset:0
  ds_read_b128 v[80:83], v18 offset:0
  ds_read_b128 v[84:87], v19 offset:0
  ds_read_b128 v[88:91], v16 offset:4096
  ds_read_b128 v[92:95], v17 offset:4096
  ds_read_b128 v[96:99], v18 offset:4096
  ds_read_b128 v[100:103], v19 offset:4096
  s_waitcnt lgkmcnt(4)
  v_mfma_f32_16x16x32_bf16 v[52:55], v[72:75], v[136:139], 0
  v_mfma_f32_16x16x32_bf16 v[52:55], v[76:79], v[140:143], v[52:55]
  v_mfma_f32_16x16x32_bf16 v[52:55], v[80:83], v[144:147], v[52:55]
  v_mfma_f32_16x16x32_bf16 v[52:55], v[84:87], v[148:151], v[52:55]
  s_waitcnt lgkmcnt(0)
  v_mfma_f32_16x16x32_bf16 v[52:55], v[88:91], v[152:155], v[52:55]
  v_mfma_f32_16x16x32_bf16 v[52:55], v[92:95], v[156:159], v[52:55]
  v_mfma_f32_16x16x32_bf16 v[52:55], v[96:99], v[160:163], v[52:55]
  v_mfma_f32_16x16x32_bf16 v[52:55], v[100:103], v[164:167], v[52:55]
  s_cmp_lg_u32 s31, 8
  s_cbranch_scc1 Lsw_8
  s_mov_b32 s52, s60
  s_mov_b32 s53, s61
  s_mov_b32 s54, s62
  s_mov_b32 s55, s63
  v_mov_b32 v12, v8
  v_mov_b32 v13, v9
  v_mov_b32 v14, v8
  v_mov_b32 v15, v9
Lsw_8:
  s_add_u32 s20, s31, s5
  s_and_b32 s20, s20, 7
  s_lshl_b32 s20, s20, 15
  s_add_u32 s32, s20, s28
  s_add_u32 s50, s20, s49
  s_and_b32 s20, s31, 3
  s_lshl_b32 s20, s20, 13
  s_add_u32 m0, s20, s30
  s_add_u32 s31, s31, 1
  s_waitcnt vmcnt(7)
  buffer_load_dwordx4 v12, s[52:55], s32 offen offset:0 nt lds
  s_waitcnt vmcnt(7)
  buffer_load_dwordx4 v13, s[52:55], s32 offen offset:1024 nt lds
  s_waitcnt vmcnt(7)
  buffer_load_dwordx4 v14, s[52:55], s32 offen offset:2048 nt lds
  s_waitcnt vmcnt(7)
  buffer_load_dwordx4 v15, s[52:55], s32 offen offset:3072 nt lds
  s_add_u32 m0, m0, 4096
  s_waitcnt vmcnt(7)
  buffer_load_dwordx4 v12, s[52:55], s50 offen offset:0 nt lds
  s_waitcnt vmcnt(7)
  buffer_load_dwordx4 v13, s[52:55], s50 offen offset:1024 nt lds
  s_waitcnt vmcnt(7)
  buffer_load_dwordx4 v14, s[52:55], s50 offen offset:2048 nt lds
  s_waitcnt vmcnt(7)
  buffer_load_dwordx4 v15, s[52:55], s50 offen offset:3072 nt lds
  ds_read_b128 v[72:75], v16 offset:8192
  ds_read_b128 v[76:79], v17 offset:8192
  ds_read_b128 v[80:83], v18 offset:8192
  ds_read_b128 v[84:87], v19 offset:8192
  ds_read_b128 v[88:91], v16 offset:12288
  ds_read_b128 v[92:95], v17 offset:12288
  ds_read_b128 v[96:99], v18 offset:12288
  ds_read_b128 v[100:103], v19 offset:12288
  s_waitcnt lgkmcnt(4)
  v_mfma_f32_16x16x32_bf16 v[52:55], v[72:75], v[168:171], v[52:55]
  v_mfma_f32_16x16x32_bf16 v[52:55], v[76:79], v[172:175], v[52:55]
  v_mfma_f32_16x16x32_bf16 v[52:55], v[80:83], v[176:179], v[52:55]
  v_mfma_f32_16x16x32_bf16 v[52:55], v[84:87], v[180:183], v[52:55]
  s_waitcnt lgkmcnt(0)
  v_mfma_f32_16x16x32_bf16 v[52:55], v[88:91], v[184:187], v[52:55]
  v_mfma_f32_16x16x32_bf16 v[52:55], v[92:95], v[188:191], v[52:55]
  v_mfma_f32_16x16x32_bf16 v[52:55], v[96:99], v[192:195], v[52:55]
  v_mfma_f32_16x16x32_bf16 v[52:55], v[100:103], v[196:199], v[52:55]
  v_mov_b32 v36, v38
  v_mov_b32 v37, v39
  v_mov_b32 v38, v40
  v_mov_b32 v39, v41
  v_mov_b32 v40, v42
  v_mov_b32 v41, v43
  v_xor_b32 v16, 0x4000, v16
  v_xor_b32 v17, 0x4000, v17
  v_xor_b32 v18, 0x4000, v18
  v_xor_b32 v19, 0x4000, v19
  v_cvt_pk_bf16_f32 v28, v52, v53
  v_cvt_pk_bf16_f32 v29, v54, v55
  v_lshlrev_b32 v30, 16, v28
  v_and_b32 v31, s43, v28
  v_lshlrev_b32 v32, 16, v29
  v_and_b32 v33, s43, v29
  v_mul_f32 v30, s42, v30
  v_mul_f32 v31, s42, v31
  v_mul_f32 v32, s42, v32
  v_mul_f32 v33, s42, v33
  v_cvt_pk_bf16_f32 v42, v30, v31
  v_cvt_pk_bf16_f32 v43, v32, v33
  s_add_u32 s33, s33, 1
  s_cmp_lt_u32 s33, 4
  s_cbranch_scc1 L_k
  v_lshlrev_b32 v56, 16, v36
  v_and_b32 v57, s43, v36
  v_lshlrev_b32 v58, 16, v37
  v_and_b32 v59, s43, v37
  v_lshlrev_b32 v60, 16, v38
  v_and_b32 v61, s43, v38
  v_lshlrev_b32 v62, 16, v39
  v_and_b32 v63, s43, v39
  v_lshlrev_b32 v64, 16, v40
  v_and_b32 v65, s43, v40
  v_lshlrev_b32 v66, 16, v41
  v_and_b32 v67, s43, v41
  v_lshlrev_b32 v68, 16, v42
  v_and_b32 v69, s43, v42
  v_lshlrev_b32 v70, 16, v43
  v_and_b32 v71, s43, v43
  v_max3_f32 v28, v56, v57, v58
  v_max3_f32 v28, v28, v59, v60
  v_max3_f32 v28, v28, v61, v62
  v_max3_f32 v28, v28, v63, v64
  v_max3_f32 v28, v28, v65, v66
  v_max3_f32 v28, v28, v67, v68
  v_max3_f32 v28, v28, v69, v70
  v_max_f32 v28, v28, v71
  s_nop 1
  v_max_f32_dpp v28, v28, v28 row_ror:4 row_mask:0xf bank_mask:0xf
  s_nop 1
  v_max_f32_dpp v28, v28, v28 row_ror:8 row_mask:0xf bank_mask:0xf
  v_mov_b32 v30, v28
  s_nop 1
  v_permlane16_swap_b32 v28, v30
  v_max_f32 v28, v28, v30
  v_mov_b32 v30, v28
  s_nop 1
  v_permlane32_swap_b32 v28, v30
  v_max_f32 v28, v28, v30
  s_mov_b32 s20, 0x3FB8AA3B
  v_mul_f32 v30, s20, v28
  v_fma_f32 v56, v56, s20, -v30
  v_fma_f32 v57, v57, s20, -v30
  v_fma_f32 v58, v58, s20, -v30
  v_fma_f32 v59, v59, s20, -v30
  v_fma_f32 v60, v60, s20, -v30
  v_fma_f32 v61, v61, s20, -v30
  v_fma_f32 v62, v62, s20, -v30
  v_fma_f32 v63, v63, s20, -v30
  v_fma_f32 v64, v64, s20, -v30
  v_fma_f32 v65, v65, s20, -v30
  v_fma_f32 v66, v66, s20, -v30
  v_fma_f32 v67, v67, s20, -v30
  v_fma_f32 v68, v68, s20, -v30
  v_fma_f32 v69, v69, s20, -v30
  v_fma_f32 v70, v70, s20, -v30
  v_fma_f32 v71, v71, s20, -v30
  v_exp_f32 v56, v56
  v_exp_f32 v57, v57
  v_exp_f32 v58, v58
  v_exp_f32 v59, v59
  v_exp_f32 v60, v60
  v_exp_f32 v61, v61
  v_exp_f32 v62, v62
  v_exp_f32 v63, v63
  v_exp_f32 v64, v64
  v_exp_f32 v65, v65
  v_exp_f32 v66, v66
  v_exp_f32 v67, v67
  v_exp_f32 v68, v68
  v_exp_f32 v69, v69
  v_exp_f32 v70, v70
  v_exp_f32 v71, v71
  s_nop 0
  v_cvt_pk_bf16_f32 v36, v56, v57
  v_cvt_pk_bf16_f32 v37, v58, v59
  v_cvt_pk_bf16_f32 v38, v60, v61
  v_cvt_pk_bf16_f32 v39, v62, v63
  v_cvt_pk_bf16_f32 v40, v64, v65
  v_cvt_pk_bf16_f32 v41, v66, v67
  v_cvt_pk_bf16_f32 v42, v68, v69
  v_cvt_pk_bf16_f32 v43, v70, v71
  v_pk_add_f32 v[56:57], v[56:57], v[64:65]
  v_pk_add_f32 v[58:59], v[58:59], v[66:67]
  v_pk_add_f32 v[60:61], v[60:61], v[68:69]
  v_pk_add_f32 v[62:63], v[62:63], v[70:71]
  v_pk_add_f32 v[56:57], v[56:57], v[60:61]
  v_pk_add_f32 v[58:59], v[58:59], v[62:63]
  v_pk_add_f32 v[56:57], v[56:57], v[58:59]
  v_add_f32 v29, v56, v57
  s_nop 1
  v_add_f32_dpp v29, v29, v29 row_ror:4 row_mask:0xf bank_mask:0xf
  s_nop 1
  v_add_f32_dpp v29, v29, v29 row_ror:8 row_mask:0xf bank_mask:0xf
  v_mov_b32 v30, v29
  s_nop 1
  v_permlane16_swap_b32 v29, v30
  v_add_f32 v29, v29, v30
  v_mov_b32 v30, v29
  s_nop 1
  v_permlane32_swap_b32 v29, v30
  v_add_f32 v29, v29, v30
  s_lshl_b32 s20, s3, 5
  v_lshlrev_b32 v30, 3, v0
  v_add_u32 v30, s20, v30
  v_add_u32 v30, v2, v30
  s_mov_b64 exec, 15
  ds_write_b64 v30, v[28:29] offset:64
  s_waitcnt lgkmcnt(0)
  s_mov_b64 exec, -1
  s_mov_b64 exec, 1
  ds_add_u32 v2, v3 offset:24
  s_mov_b64 exec, -1
  v_and_b32 v31, 15, v0
  v_lshrrev_b32 v30, 4, v0
  v_lshlrev_b32 v60, 9, v31
  v_lshl_add_u32 v60, v30, 4, v60
  v_add_u32 v60, s30, v60
  v_cmp_gt_u32 s[34:35], 4, v31
  s_lshl_b32 s20, s3, 9
  v_and_b32 v61, 31, v0
  v_lshlrev_b32 v61, 4, v61
  v_add_u32 v61, s20, v61
  s_lshl_b32 s20, s3, 4
  v_add_u32 v62, s20, v2
  v_bfe_u32 v63, v0, 3, 2
  v_lshlrev_b32 v63, 11, v63
  v_and_b32 v30, 7, v0
  v_lshl_add_u32 v63, v30, 4, v63
  s_lshl_b32 s36, s4, 2
  s_add_u32 s36, s36, s3
  s_lshl_b32 s36, s36, 14
  s_lshr_b32 s21, s5, 4
  s_lshl_b32 s21, s21, 13
  s_add_u32 s36, s36, s21
  s_and_b32 s21, s5, 15
  s_lshl_b32 s21, s21, 7
  s_add_u32 s36, s36, s21
  s_add_u32 s36, s36, 1048576
  s_add_u32 s21, s48, 1
  s_and_b32 s21, s21, 0xff
  v_mov_b32 v64, s21
  s_mov_b32 s38, 0xffff0000
  v_mov_b32 v104, 0
  v_mov_b32 v105, 0
  v_mov_b32 v106, 0
  v_mov_b32 v107, 0
  v_mov_b32 v108, 0
  v_mov_b32 v109, 0
  v_mov_b32 v110, 0
  v_mov_b32 v111, 0
  v_mov_b32 v112, 0
  v_mov_b32 v113, 0
  v_mov_b32 v114, 0
  v_mov_b32 v115, 0
  v_mov_b32 v116, 0
  v_mov_b32 v117, 0
  v_mov_b32 v118, 0
  v_mov_b32 v119, 0
  v_mov_b32 v120, 0
  v_mov_b32 v121, 0
  v_mov_b32 v122, 0
  v_mov_b32 v123, 0
  v_mov_b32 v124, 0
  v_mov_b32 v125, 0
  v_mov_b32 v126, 0
  v_mov_b32 v127, 0
  v_mov_b32 v128, 0
  v_mov_b32 v129, 0
  v_mov_b32 v130, 0
  v_mov_b32 v131, 0
  v_mov_b32 v132, 0
  v_mov_b32 v133, 0
  v_mov_b32 v134, 0
  v_mov_b32 v135, 0
  s_mov_b32 s33, 0
L_v:
  v_mov_b32 v44, v36
  v_mov_b32 v45, v37
  v_mov_b32_dpp v46, v36 row_shl:4 row_mask:0xf bank_mask:0xf bound_ctrl:0
  v_mov_b32_dpp v47, v37 row_shl:4 row_mask:0xf bank_mask:0xf bound_ctrl:0
  v_mov_b32_dpp v48, v36 row_shl:8 row_mask:0xf bank_mask:0xf bound_ctrl:0
  v_mov_b32_dpp v49, v37 row_shl:8 row_mask:0xf bank_mask:0xf bound_ctrl:0
  v_mov_b32_dpp v50, v36 row_shl:12 row_mask:0xf bank_mask:0xf bound_ctrl:0
  v_mov_b32_dpp v51, v37 row_shl:12 row_mask:0xf bank_mask:0xf bound_ctrl:0
  v_mov_b32 v36, v38
  v_mov_b32 v37, v39
  v_mov_b32 v38, v40
  v_mov_b32 v39, v41
  v_mov_b32 v40, v42
  v_mov_b32 v41, v43
  s_cmp_lg_u32 s3, 0
  s_cbranch_scc1 Lew_10
  s_cmp_lg_u32 s33, 1
  s_cbranch_scc1 Lew_11
  s_mov_b64 exec, 1
  ds_add_u32 v2, v3 offset:48
  s_mov_b64 exec, -1
Lew_11:
  s_cmp_lg_u32 s33, 3
  s_cbranch_scc1 Lew_9
  s_mov_b64 exec, 1
  ds_add_u32 v2, v3 offset:52
  s_mov_b64 exec, -1
Lew_10:
  s_cmp_lg_u32 s33, 3
  s_cbranch_scc1 Lew_9
  s_mov_b32 s6, 0
Lw_12:
  ds_read_b32 v33, v2 offset:56
  s_waitcnt lgkmcnt(0)
  v_readfirstlane_b32 s27, v33
  s_cmp_ge_u32 s27, 1
  s_cbranch_scc1 Lwd_13
  s_add_u32 s6, s6, 1
  s_cmp_lt_u32 s6, 4000000
  s_cbranch_scc0 Lwd_13
  s_sleep 0
  s_branch Lw_12
Lwd_13:
  s_lshr_b32 s51, s27, 1
  s_mov_b32 s6, 0
Lw_14:
  ds_read_b32 v33, v2 offset:12
  s_waitcnt lgkmcnt(0)
  v_readfirstlane_b32 s27, v33
  s_cmp_ge_u32 s27, 1
  s_cbranch_scc1 Lwd_15
  s_add_u32 s6, s6, 1
  s_cmp_lt_u32 s6, 4000000
  s_cbranch_scc0 Lwd_15
  s_sleep 0
  s_branch Lw_14
Lwd_15:
Lew_9:
  s_add_u32 s20, s31, s5
  s_and_b32 s20, s20, 7
  s_lshl_b32 s20, s20, 15
  s_add_u32 s32, s20, s28
  s_add_u32 s50, s20, s49
  s_and_b32 s20, s31, 3
  s_lshl_b32 s20, s20, 13
  s_add_u32 m0, s20, s30
  s_add_u32 s31, s31, 1
  s_waitcnt vmcnt(7)
  buffer_load_dwordx4 v12, s[52:55], s32 offen offset:0 nt lds
  s_waitcnt vmcnt(7)
  buffer_load_dwordx4 v13, s[52:55], s32 offen offset:1024 nt lds
  s_waitcnt vmcnt(7)
  buffer_load_dwordx4 v14, s[52:55], s32 offen offset:2048 nt lds
  s_waitcnt vmcnt(7)
  buffer_load_dwordx4 v15, s[52:55], s32 offen offset:3072 nt lds
  s_add_u32 m0, m0, 4096
  s_waitcnt vmcnt(7)
  buffer_load_dwordx4 v12, s[52:55], s50 offen offset:0 nt lds
  s_waitcnt vmcnt(7)
  buffer_load_dwordx4 v13, s[52:55], s50 offen offset:1024 nt lds
  s_waitcnt vmcnt(7)
  buffer_load_dwordx4 v14, s[52:55], s50 offen offset:2048 nt lds
  s_waitcnt vmcnt(7)
  buffer_load_dwordx4 v15, s[52:55], s50 offen offset:3072 nt lds
  ds_read_b64_tr_b16 v[72:73], v20 offset:0
  ds_read_b64_tr_b16 v[74:75], v20 offset:4096
  ds_read_b64_tr_b16 v[76:77], v21 offset:0
  ds_read_b64_tr_b16 v[78:79], v21 offset:4096
  ds_read_b64_tr_b16 v[80:81], v22 offset:0
  ds_read_b64_tr_b16 v[82:83], v22 offset:4096
  ds_read_b64_tr_b16 v[84:85], v23 offset:0
  ds_read_b64_tr_b16 v[86:87], v23 offset:4096
  ds_read_b64_tr_b16 v[88:89], v24 offset:0
  ds_read_b64_tr_b16 v[90:91], v24 offset:4096
  ds_read_b64_tr_b16 v[92:93], v25 offset:0
  ds_read_b64_tr_b16 v[94:95], v25 offset:4096
  ds_read_b64_tr_b16 v[96:97], v26 offset:0
  ds_read_b64_tr_b16 v[98:99], v26 offset:4096
  ds_read_b64_tr_b16 v[100:101], v27 offset:0
  ds_read_b64_tr_b16 v[102:103], v27 offset:4096
  s_waitcnt lgkmcnt(12)
  v_mfma_f32_16x16x32_bf16 v[104:107], v[72:75], v[44:47], v[104:107]
  v_mfma_f32_16x16x32_bf16 v[108:111], v[76:79], v[44:47], v[108:111]
  s_waitcnt lgkmcnt(8)
  v_mfma_f32_16x16x32_bf16 v[112:115], v[80:83], v[44:47], v[112:115]
  v_mfma_f32_16x16x32_bf16 v[116:119], v[84:87], v[44:47], v[116:119]
  s_waitcnt lgkmcnt(4)
  v_mfma_f32_16x16x32_bf16 v[120:123], v[88:91], v[44:47], v[120:123]
  v_mfma_f32_16x16x32_bf16 v[124:127], v[92:95], v[44:47], v[124:127]
  s_waitcnt lgkmcnt(0)
  v_mfma_f32_16x16x32_bf16 v[128:131], v[96:99], v[44:47], v[128:131]
  v_mfma_f32_16x16x32_bf16 v[132:135], v[100:103], v[44:47], v[132:135]
  s_cmp_ge_u32 s33, 3
  s_cbranch_scc1 Lve_16
  s_add_u32 s20, s31, s5
  s_and_b32 s20, s20, 7
  s_lshl_b32 s20, s20, 15
  s_add_u32 s32, s20, s28
  s_add_u32 s50, s20, s49
  s_and_b32 s20, s31, 3
  s_lshl_b32 s20, s20, 13
  s_add_u32 m0, s20, s30
  s_add_u32 s31, s31, 1
  s_waitcnt vmcnt(7)
  buffer_load_dwordx4 v12, s[52:55], s32 offen offset:0 nt lds
  s_waitcnt vmcnt(7)
  buffer_load_dwordx4 v13, s[52:55], s32 offen offset:1024 nt lds
  s_waitcnt vmcnt(7)
  buffer_load_dwordx4 v14, s[52:55], s32 offen offset:2048 nt lds
  s_waitcnt vmcnt(7)
  buffer_load_dwordx4 v15, s[52:55], s32 offen offset:3072 nt lds
  s_add_u32 m0, m0, 4096
  s_waitcnt vmcnt(7)
  buffer_load_dwordx4 v12, s[52:55], s50 offen offset:0 nt lds
  s_waitcnt vmcnt(7)
  buffer_load_dwordx4 v13, s[52:55], s50 offen offset:1024 nt lds
  s_waitcnt vmcnt(7)
  buffer_load_dwordx4 v14, s[52:55], s50 offen offset:2048 nt lds
  s_waitcnt vmcnt(7)
  buffer_load_dwordx4 v15, s[52:55], s50 offen offset:3072 nt lds
  s_branch Lvd_17
Lve_16:
  s_waitcnt vmcnt(0)
Lvd_17:
  ds_read_b64_tr_b16 v[72:73], v20 offset:8192
  ds_read_b64_tr_b16 v[74:75], v20 offset:12288
  ds_read_b64_tr_b16 v[76:77], v21 offset:8192
  ds_read_b64_tr_b16 v[78:79], v21 offset:12288
  ds_read_b64_tr_b16 v[80:81], v22 offset:8192
  ds_read_b64_tr_b16 v[82:83], v22 offset:12288
  ds_read_b64_tr_b16 v[84:85], v23 offset:8192
  ds_read_b64_tr_b16 v[86:87], v23 offset:12288
  ds_read_b64_tr_b16 v[88:89], v24 offset:8192
  ds_read_b64_tr_b16 v[90:91], v24 offset:12288
  ds_read_b64_tr_b16 v[92:93], v25 offset:8192
  ds_read_b64_tr_b16 v[94:95], v25 offset:12288
  ds_read_b64_tr_b16 v[96:97], v26 offset:8192
  ds_read_b64_tr_b16 v[98:99], v26 offset:12288
  ds_read_b64_tr_b16 v[100:101], v27 offset:8192
  ds_read_b64_tr_b16 v[102:103], v27 offset:12288
  s_waitcnt lgkmcnt(12)
  v_mfma_f32_16x16x32_bf16 v[104:107], v[72:75], v[48:51], v[104:107]
  v_mfma_f32_16x16x32_bf16 v[108:111], v[76:79], v[48:51], v[108:111]
  s_waitcnt lgkmcnt(8)
  v_mfma_f32_16x16x32_bf16 v[112:115], v[80:83], v[48:51], v[112:115]
  v_mfma_f32_16x16x32_bf16 v[116:119], v[84:87], v[48:51], v[116:119]
  s_waitcnt lgkmcnt(4)
  v_mfma_f32_16x16x32_bf16 v[120:123], v[88:91], v[48:51], v[120:123]
  v_mfma_f32_16x16x32_bf16 v[124:127], v[92:95], v[48:51], v[124:127]
  s_waitcnt lgkmcnt(0)
  v_mfma_f32_16x16x32_bf16 v[128:131], v[96:99], v[48:51], v[128:131]
  v_mfma_f32_16x16x32_bf16 v[132:135], v[100:103], v[48:51], v[132:135]
  v_xor_b32 v20, 0x4000, v20
  v_xor_b32 v21, 0x4000, v21
  v_xor_b32 v22, 0x4000, v22
  v_xor_b32 v23, 0x4000, v23
  v_xor_b32 v24, 0x4000, v24
  v_xor_b32 v25, 0x4000, v25
  v_xor_b32 v26, 0x4000, v26
  v_xor_b32 v27, 0x4000, v27
  s_add_u32 s33, s33, 1
  s_cmp_lt_u32 s33, 4
  s_cbranch_scc1 L_v
  s_mov_b64 exec, s[34:35]
  ds_write_b128 v60, v[104:107] offset:0
  ds_write_b128 v60, v[108:111] offset:64
  ds_write_b128 v60, v[112:115] offset:128
  ds_write_b128 v60, v[116:119] offset:192
  ds_write_b128 v60, v[120:123] offset:256
  ds_write_b128 v60, v[124:127] offset:320
  ds_write_b128 v60, v[128:131] offset:384
  ds_write_b128 v60, v[132:135] offset:448
  s_mov_b64 exec, -1
  s_waitcnt lgkmcnt(0)
  s_mov_b64 exec, 1
  ds_add_u32 v2, v3 offset:4
  s_mov_b64 exec, -1
  s_mov_b32 s6, 0
Lw_18:
  ds_read_b32 v33, v2 offset:4
  s_waitcnt lgkmcnt(0)
  v_readfirstlane_b32 s27, v33
  s_cmp_ge_u32 s27, 4
  s_cbranch_scc1 Lwd_19
  s_add_u32 s6, s6, 1
  s_cmp_lt_u32 s6, 4000000
  s_cbranch_scc0 Lwd_19
  s_sleep 0
  s_branch Lw_18
Lwd_19:
  ds_read_b128 v[72:75], v61 offset:0
  ds_read_b128 v[76:79], v61 offset:32768
  v_add_u32 v61, 0x10000, v61
  ds_read_b128 v[80:83], v61 offset:0
  ds_read_b128 v[84:87], v61 offset:32768
  ds_read_b128 v[56:59], v62 offset:192
  s_waitcnt lgkmcnt(0)
  v_mul_f32 v104, v72, v56
  v_mul_f32 v105, v73, v56
  v_mul_f32 v106, v74, v56
  v_mul_f32 v107, v75, v56
  v_fmac_f32 v104, v76, v57
  v_fmac_f32 v105, v77, v57
  v_fmac_f32 v106, v78, v57
  v_fmac_f32 v107, v79, v57
  v_fmac_f32 v104, v80, v58
  v_fmac_f32 v105, v81, v58
  v_fmac_f32 v106, v82, v58
  v_fmac_f32 v107, v83, v58
  v_fmac_f32 v104, v84, v59
  v_fmac_f32 v105, v85, v59
  v_fmac_f32 v106, v86, v59
  v_fmac_f32 v107, v87, v59
  v_cvt_pk_bf16_f32 v104, v104, v104
  v_cvt_pk_bf16_f32 v105, v105, v105
  v_cvt_pk_bf16_f32 v106, v106, v106
  v_cvt_pk_bf16_f32 v107, v107, v107
  v_and_or_b32 v104, v104, s38, v64
  v_and_or_b32 v105, v105, s38, v64
  v_and_or_b32 v106, v106, s38, v64
  v_and_or_b32 v107, v107, s38, v64
  s_mov_b32 exec_hi, 0
  s_cmp_eq_u32 s51, 0
  s_cbranch_scc1 Lsl_20
  buffer_store_dwordx4 v[104:107], v63, s[16:19], s36 offen
  s_branch Lsl_21
Lsl_20:
  buffer_store_dwordx4 v[104:107], v63, s[16:19], s36 offen sc1
Lsl_21:
  s_mov_b64 exec, -1
  s_cmp_lg_u32 s3, 0
  s_cbranch_scc1 L_S_done
  s_barrier
L_S_done:
  s_endpgm
L_H2:
  s_load_dwordx2 s[36:37], s[0:1], 64
  s_load_dwordx2 s[40:41], s[0:1], 32
  s_load_dwordx2 s[44:45], s[0:1], 72
  s_load_dwordx2 s[64:65], s[0:1], 80
  s_lshr_b32 s24, s5, 3
  s_lshl_b32 s24, s24, 3
  s_add_u32 s24, s24, s4
  s_cmp_lt_u32 s24, 28
  s_cselect_b32 s3, 1, 0
  s_min_u32 s24, s24, 27
  s_lshl_b32 s49, s24, 3
  s_and_b32 s25, s5, 7
  s_add_u32 s49, s49, s25
  s_and_b32 s55, s49, 3
  s_lshl_b32 s23, s55, 2
  s_add_u32 s23, s23, s7
  s_mul_i32 s23, s23, 114688
  s_lshl_b32 s24, s24, 7
  s_add_u32 s23, s23, s24
  s_bitcmp1_b32 s49, 2
  s_cselect_b32 s32, s58, s56
  s_cselect_b32 s33, s59, s57
  s_mov_b32 s34, 1835008
  s_mov_b32 s35, 0x20000
  v_lshl_add_u32 v148, v9, 10, v10
  v_mul_u32_u24 v9, 3584, v9
  v_add_u32 v9, v9, v10
  s_add_u32 m0, s21, 65536
  s_mov_b32 s48, 0xffff0000
  buffer_load_dwordx4 v9, s[32:35], s23 offen nt lds
  s_add_u32 m0, s21, 66560
  s_add_u32 s23, s23, 28672
  buffer_load_dwordx4 v9, s[32:35], s23 offen nt lds
  s_add_u32 m0, s21, 67584
  s_add_u32 s23, s23, 28672
  buffer_load_dwordx4 v9, s[32:35], s23 offen nt lds
  s_add_u32 m0, s21, 68608
  s_add_u32 s23, s23, 28672
  buffer_load_dwordx4 v9, s[32:35], s23 offen nt lds
  v_lshrrev_b32 v4, 4, v0
  v_and_b32 v5, 15, v0
  v_mov_b32 v2, 157184
  v_mov_b32 v3, 1
  v_mul_u32_u24 v6, 1040, v6
  v_add_u32 v6, v6, v7
  v_add_u32 v144, 131072, v6
  s_mov_b32 s18, 0x10000000
  s_mov_b32 s19, 0x20000
  s_mov_b32 s38, 1835008
  s_mov_b32 s39, 0x20000
  s_mov_b32 s42, 4194304
  s_mov_b32 s43, 0x20000
  s_mov_b32 s46, 8192
  s_mov_b32 s47, 0x20000
  s_mov_b32 s30, 0xffffff00
  s_mov_b32 s50, 0x0c0c0400
  s_mov_b32 s54, 0x04000c0c
  s_waitcnt vmcnt(8)
  v_lshlrev_b32 v24, 16, v16
  v_and_b32 v25, s48, v16
  v_lshlrev_b32 v26, 16, v17
  v_and_b32 v27, s48, v17
  v_lshlrev_b32 v28, 16, v18
  v_and_b32 v29, s48, v18
  v_lshlrev_b32 v30, 16, v19
  v_and_b32 v31, s48, v19
  v_lshlrev_b32 v32, 16, v20
  v_and_b32 v33, s48, v20
  v_lshlrev_b32 v34, 16, v21
  v_and_b32 v35, s48, v21
  v_lshlrev_b32 v36, 16, v22
  v_and_b32 v37, s48, v22
  v_lshlrev_b32 v38, 16, v23
  v_and_b32 v39, s48, v23
  v_pk_add_f32 v[40:41], v[24:25], v[26:27]
  v_pk_add_f32 v[42:43], v[28:29], v[30:31]
  v_pk_add_f32 v[44:45], v[32:33], v[34:35]
  v_pk_add_f32 v[46:47], v[36:37], v[38:39]
  v_pk_add_f32 v[40:41], v[40:41], v[42:43]
  v_pk_add_f32 v[44:45], v[44:45], v[46:47]
  v_pk_add_f32 v[40:41], v[40:41], v[44:45]
  v_add_f32 v152, v40, v41
  s_nop 1
  v_add_f32_dpp v152, v152, v152 row_ror:1 row_mask:0xf bank_mask:0xf
  s_nop 1
  v_add_f32_dpp v152, v152, v152 row_ror:2 row_mask:0xf bank_mask:0xf
  s_nop 1
  v_add_f32_dpp v152, v152, v152 row_ror:4 row_mask:0xf bank_mask:0xf
  s_nop 1
  v_add_f32_dpp v152, v152, v152 row_ror:8 row_mask:0xf bank_mask:0xf
  v_mov_b32 v6, v152
  s_nop 1
  v_permlane16_swap_b32 v152, v6
  v_add_f32 v152, v152, v6
  v_mul_f32 v152, 0x3b000000, v152
  v_pk_add_f32 v[40:41], v[24:25], v[152:153] op_sel_hi:[1,0] neg_lo:[0,1] neg_hi:[0,1]
  v_pk_add_f32 v[42:43], v[26:27], v[152:153] op_sel_hi:[1,0] neg_lo:[0,1] neg_hi:[0,1]
  v_pk_add_f32 v[44:45], v[28:29], v[152:153] op_sel_hi:[1,0] neg_lo:[0,1] neg_hi:[0,1]
  v_pk_add_f32 v[46:47], v[30:31], v[152:153] op_sel_hi:[1,0] neg_lo:[0,1] neg_hi:[0,1]
  v_pk_add_f32 v[48:49], v[32:33], v[152:153] op_sel_hi:[1,0] neg_lo:[0,1] neg_hi:[0,1]
  v_pk_add_f32 v[50:51], v[34:35], v[152:153] op_sel_hi:[1,0] neg_lo:[0,1] neg_hi:[0,1]
  v_pk_add_f32 v[52:53], v[36:37], v[152:153] op_sel_hi:[1,0] neg_lo:[0,1] neg_hi:[0,1]
  v_pk_add_f32 v[54:55], v[38:39], v[152:153] op_sel_hi:[1,0] neg_lo:[0,1] neg_hi:[0,1]
  v_pk_mul_f32 v[154:155], v[40:41], v[40:41]
  v_pk_fma_f32 v[154:155], v[42:43], v[42:43], v[154:155]
  v_pk_fma_f32 v[154:155], v[44:45], v[44:45], v[154:155]
  v_pk_fma_f32 v[154:155], v[46:47], v[46:47], v[154:155]
  v_pk_fma_f32 v[154:155], v[48:49], v[48:49], v[154:155]
  v_pk_fma_f32 v[154:155], v[50:51], v[50:51], v[154:155]
  v_pk_fma_f32 v[154:155], v[52:53], v[52:53], v[154:155]
  v_pk_fma_f32 v[154:155], v[54:55], v[54:55], v[154:155]
  v_add_f32 v154, v154, v155
  s_nop 1
  v_add_f32_dpp v154, v154, v154 row_ror:1 row_mask:0xf bank_mask:0xf
  s_nop 1
  v_add_f32_dpp v154, v154, v154 row_ror:2 row_mask:0xf bank_mask:0xf
  s_nop 1
  v_add_f32_dpp v154, v154, v154 row_ror:4 row_mask:0xf bank_mask:0xf
  s_nop 1
  v_add_f32_dpp v154, v154, v154 row_ror:8 row_mask:0xf bank_mask:0xf
  v_mov_b32 v6, v154
  s_nop 1
  v_permlane16_swap_b32 v154, v6
  v_add_f32 v154, v154, v6
  v_mul_f32 v154, 0x3b000000, v154
  v_cvt_pk_bf16_f32 v152, v152, v154
  v_and_b32 v154, s48, v152
  v_lshlrev_b32 v152, 16, v152
  v_add_f32 v154, 0x3727c5ac, v154
  v_cvt_pk_bf16_f32 v154, v154, v154
  v_and_b32 v154, s48, v154
  v_sqrt_f32 v154, v154
  s_nop 0
  v_cvt_pk_bf16_f32 v154, v154, v154
  v_and_b32 v154, s48, v154
  v_rcp_f32 v154, v154
  v_pk_add_f32 v[40:41], v[24:25], v[152:153] op_sel_hi:[1,0] neg_lo:[0,1] neg_hi:[0,1]
  v_pk_add_f32 v[42:43], v[26:27], v[152:153] op_sel_hi:[1,0] neg_lo:[0,1] neg_hi:[0,1]
  v_pk_add_f32 v[44:45], v[28:29], v[152:153] op_sel_hi:[1,0] neg_lo:[0,1] neg_hi:[0,1]
  v_pk_add_f32 v[46:47], v[30:31], v[152:153] op_sel_hi:[1,0] neg_lo:[0,1] neg_hi:[0,1]
  v_pk_add_f32 v[48:49], v[32:33], v[152:153] op_sel_hi:[1,0] neg_lo:[0,1] neg_hi:[0,1]
  v_pk_add_f32 v[50:51], v[34:35], v[152:153] op_sel_hi:[1,0] neg_lo:[0,1] neg_hi:[0,1]
  v_pk_add_f32 v[52:53], v[36:37], v[152:153] op_sel_hi:[1,0] neg_lo:[0,1] neg_hi:[0,1]
  v_pk_add_f32 v[54:55], v[38:39], v[152:153] op_sel_hi:[1,0] neg_lo:[0,1] neg_hi:[0,1]
  v_cvt_pk_bf16_f32 v16, v40, v41
  v_cvt_pk_bf16_f32 v17, v42, v43
  v_cvt_pk_bf16_f32 v18, v44, v45
  v_cvt_pk_bf16_f32 v19, v46, v47
  v_cvt_pk_bf16_f32 v20, v48, v49
  v_cvt_pk_bf16_f32 v21, v50, v51
  v_cvt_pk_bf16_f32 v22, v52, v53
  v_cvt_pk_bf16_f32 v23, v54, v55
  v_lshlrev_b32 v24, 16, v16
  v_and_b32 v25, s48, v16
  v_lshlrev_b32 v26, 16, v17
  v_and_b32 v27, s48, v17
  v_lshlrev_b32 v28, 16, v18
  v_and_b32 v29, s48, v18
  v_lshlrev_b32 v30, 16, v19
  v_and_b32 v31, s48, v19
  v_lshlrev_b32 v32, 16, v20
  v_and_b32 v33, s48, v20
  v_lshlrev_b32 v34, 16, v21
  v_and_b32 v35, s48, v21
  v_lshlrev_b32 v36, 16, v22
  v_and_b32 v37, s48, v22
  v_lshlrev_b32 v38, 16, v23
  v_and_b32 v39, s48, v23
  v_pk_mul_f32 v[40:41], v[24:25], v[154:155] op_sel_hi:[1,0]
  v_pk_mul_f32 v[42:43], v[26:27], v[154:155] op_sel_hi:[1,0]
  v_pk_mul_f32 v[44:45], v[28:29], v[154:155] op_sel_hi:[1,0]
  v_pk_mul_f32 v[46:47], v[30:31], v[154:155] op_sel_hi:[1,0]
  v_pk_mul_f32 v[48:49], v[32:33], v[154:155] op_sel_hi:[1,0]
  v_pk_mul_f32 v[50:51], v[34:35], v[154:155] op_sel_hi:[1,0]
  v_pk_mul_f32 v[52:53], v[36:37], v[154:155] op_sel_hi:[1,0]
  v_pk_mul_f32 v[54:55], v[38:39], v[154:155] op_sel_hi:[1,0]
  v_cvt_pk_bf16_f32 v16, v40, v41
  v_cvt_pk_bf16_f32 v17, v42, v43
  v_cvt_pk_bf16_f32 v18, v44, v45
  v_cvt_pk_bf16_f32 v19, v46, v47
  v_cvt_pk_bf16_f32 v20, v48, v49
  v_cvt_pk_bf16_f32 v21, v50, v51
  v_cvt_pk_bf16_f32 v22, v52, v53
  v_cvt_pk_bf16_f32 v23, v54, v55
  ds_write_b128 v144, v[16:19]
  ds_write_b128 v144, v[20:23] offset:16
  v_lshrrev_b32 v6, 2, v5
  v_lshl_add_u32 v6, v4, 3, v6
  v_lshlrev_b32 v6, 7, v6
  v_and_b32 v7, 3, v5
  v_lshl_add_u32 v149, v7, 3, v6
  s_lshl_b32 s20, s7, 5
  s_add_u32 s20, s20, 24576
  v_add_u32 v145, s20, v149
  v_and_b32 v6, 7, v5
  v_mul_u32_u24 v6, 1040, v6
  v_lshl_add_u32 v6, v4, 4, v6
  v_add_u32 v146, 131072, v6
  v_cmp_gt_u32 s[60:61], 8, v5
  s_waitcnt vmcnt(4) lgkmcnt(0)
  s_add_u32 s29, s28, 1
  s_and_b32 s29, s29, 0xff
  s_mul_i32 s31, s29, 0x01010101
  v_mov_b32 v156, s29
  v_mov_b32 v197, 0x80
  s_cmp_lg_u32 s7, 1
  s_cbranch_scc1 Lc_22
  s_mov_b32 s66, 256
  s_mov_b32 s67, 0x20000
  s_getreg_b32 s24, hwreg(HW_REG_XCC_ID, 0, 3)
  s_lshl_b32 s24, s24, 3
  s_lshl_b64 s[26:27], 1, s24
  v_mov_b32 v56, s26
  v_mov_b32 v57, s27
  s_lshl_b32 s24, s4, 5
  v_mov_b32 v6, s24
  s_mov_b64 exec, 1
  buffer_atomic_add_x2 v[56:57], v6, s[64:67], 0 offen sc1
  s_mov_b64 exec, -1
Lc_22:
  s_mov_b64 exec, 1
  ds_add_u32 v2, v3 offset:0
  s_mov_b64 exec, -1
  s_mov_b32 s6, 0
Lw_23:
  ds_read_b32 v11, v2 offset:0
  s_waitcnt lgkmcnt(0)
  v_readfirstlane_b32 s27, v11
  s_cmp_ge_u32 s27, 4
  s_cbranch_scc1 Lwd_24
  s_add_u32 s6, s6, 1
  s_cmp_lt_u32 s6, 4000000
  s_cbranch_scc0 Lwd_24
  s_sleep 1
  s_branch Lw_23
Lwd_24:
  s_lshl_b32 s20, s52, 8
  v_add_u32 v6, s20, v146
  ds_read_b64_tr_b16 v[56:57], v145 offset:0
  ds_read_b64_tr_b16 v[58:59], v145 offset:512
  ds_read_b128 v[72:75], v6 offset:0
  ds_read_b64_tr_b16 v[60:61], v145 offset:4096
  ds_read_b64_tr_b16 v[62:63], v145 offset:4608
  ds_read_b128 v[76:79], v6 offset:64
  ds_read_b64_tr_b16 v[64:65], v145 offset:32768
  ds_read_b64_tr_b16 v[66:67], v145 offset:33280
  ds_read_b128 v[80:83], v6 offset:128
  ds_read_b64_tr_b16 v[68:69], v145 offset:36864
  ds_read_b64_tr_b16 v[70:71], v145 offset:37376
  ds_read_b128 v[84:87], v6 offset:192
  s_waitcnt lgkmcnt(9)
  v_mfma_f32_16x16x32_bf16 v[88:91], v[56:59], v[72:75], 0
  s_waitcnt lgkmcnt(6)
  v_mfma_f32_16x16x32_bf16 v[88:91], v[60:63], v[76:79], v[88:91]
  s_waitcnt lgkmcnt(3)
  v_mfma_f32_16x16x32_bf16 v[88:91], v[64:67], v[80:83], v[88:91]
  s_waitcnt lgkmcnt(0)
  v_mfma_f32_16x16x32_bf16 v[88:91], v[68:71], v[84:87], v[88:91]
  v_lshlrev_b32 v6, 11, v5
  v_lshl_add_u32 v6, v4, 4, v6
  s_lshl_b32 s20, s7, 6
  v_add_u32 v6, s20, v6
  s_lshl_b32 s62, s4, 2
  s_add_u32 s62, s62, s52
  s_lshl_b32 s20, s62, 14
  s_lshl_b32 s21, s51, 8
  s_add_u32 s20, s20, s21
  v_and_or_b32 v88, v88, s30, v156
  v_and_or_b32 v89, v89, s30, v156
  v_and_or_b32 v90, v90, s30, v156
  v_and_or_b32 v91, v91, s30, v156
  s_mov_b64 exec, s[60:61]
  buffer_store_dwordx4 v[88:91], v6, s[16:19], s20 offen sc1
  s_mov_b64 exec, -1
  s_lshl_b32 s63, s7, 12
  s_add_u32 s63, s63, 140800
  s_lshl_b32 s20, s62, 2
  s_add_u32 s20, s20, s7
  s_lshl_b32 s20, s20, 15
  s_lshl_b32 s21, s51, 7
  s_add_u32 s20, s20, s21
  s_add_u32 m0, s63, 0
  s_nop 0
  buffer_load_dwordx4 v148, s[40:43], s20 offen nt lds
  s_add_u32 m0, s63, 1024
  s_add_u32 s20, s20, 8192
  buffer_load_dwordx4 v148, s[40:43], s20 offen nt lds
  s_add_u32 m0, s63, 2048
  s_add_u32 s20, s20, 8192
  buffer_load_dwordx4 v148, s[40:43], s20 offen nt lds
  s_add_u32 m0, s63, 3072
  s_add_u32 s20, s20, 8192
  buffer_load_dwordx4 v148, s[40:43], s20 offen nt lds
  s_waitcnt vmcnt(5)
  s_mov_b64 exec, 1
  ds_add_u32 v2, v3 offset:8
  s_mov_b64 exec, -1
  s_mov_b32 s6, 0
Lw_25:
  ds_read_b32 v11, v2 offset:8
  s_waitcnt lgkmcnt(0)
  v_readfirstlane_b32 s27, v11
  s_cmp_ge_u32 s27, 4
  s_cbranch_scc1 Lwd_26
  s_add_u32 s6, s6, 1
  s_cmp_lt_u32 s6, 4000000
  s_cbranch_scc0 Lwd_26
  s_sleep 1
  s_branch Lw_25
Lwd_26:
  s_lshl_b32 s20, s55, 8
  v_add_u32 v6, s20, v146
  v_add_u32 v7, 0x10000, v145
  ds_read_b64_tr_b16 v[56:57], v7 offset:0
  ds_read_b64_tr_b16 v[58:59], v7 offset:512
  ds_read_b128 v[72:75], v6 offset:0
  ds_read_b64_tr_b16 v[60:61], v7 offset:4096
  ds_read_b64_tr_b16 v[62:63], v7 offset:4608
  ds_read_b128 v[76:79], v6 offset:64
  ds_read_b64_tr_b16 v[64:65], v7 offset:32768
  ds_read_b64_tr_b16 v[66:67], v7 offset:33280
  ds_read_b128 v[80:83], v6 offset:128
  ds_read_b64_tr_b16 v[68:69], v7 offset:36864
  ds_read_b64_tr_b16 v[70:71], v7 offset:37376
  ds_read_b128 v[84:87], v6 offset:192
  s_waitcnt lgkmcnt(9)
  v_mfma_f32_16x16x32_bf16 v[88:91], v[56:59], v[72:75], 0
  s_waitcnt lgkmcnt(6)
  v_mfma_f32_16x16x32_bf16 v[88:91], v[60:63], v[76:79], v[88:91]
  s_waitcnt lgkmcnt(3)
  v_mfma_f32_16x16x32_bf16 v[88:91], v[64:67], v[80:83], v[88:91]
  s_waitcnt lgkmcnt(0)
  v_mfma_f32_16x16x32_bf16 v[88:91], v[68:71], v[84:87], v[88:91]
  s_mov_b64 exec, 1
  ds_add_u32 v2, v3 offset:20
  s_mov_b64 exec, -1
  v_lshlrev_b32 v6, 8, v5
  v_lshl_add_u32 v6, v4, 4, v6
  s_lshl_b32 s20, s7, 6
  v_add_u32 v6, s20, v6
  s_and_b32 s20, s49, 7
  s_mul_i32 s20, s20, 28
  s_lshr_b32 s21, s49, 3
  s_add_u32 s20, s20, s21
  s_lshl_b32 s20, s20, 11
  s_add_u32 s20, s20, 524288
  v_and_or_b32 v88, v88, s30, v156
  v_and_or_b32 v89, v89, s30, v156
  v_and_or_b32 v90, v90, s30, v156
  v_and_or_b32 v91, v91, s30, v156
  s_cmp_eq_u32 s3, 0
  s_cbranch_scc1 Lg_27
  s_mov_b64 exec, s[60:61]
  buffer_store_dwordx4 v[88:91], v6, s[16:19], s20 offen sc1
  s_mov_b64 exec, -1
Lg_27:
  v_lshrrev_b32 v6, 5, v0
  v_lshlrev_b32 v6, 14, v6
  v_and_b32 v7, 31, v0
  v_lshl_add_u32 v6, v7, 4, v6
  s_lshl_b32 s20, s7, 9
  v_add_u32 v6, s20, v6
  s_lshl_b32 s20, s4, 16
  s_lshl_b32 s21, s51, 11
  s_add_u32 s20, s20, s21
  s_add_u32 s21, s20, 32768
  s_mul_i32 s22, s7, 272
  s_add_u32 s22, s22, 139520
  v_lshlrev_b32 v7, 3, v7
  v_add_u32 v7, s22, v7
  s_mov_b32 s6, 0
Lr_28:
  buffer_load_dwordx4 v[56:59], v6, s[16:19], s20 offen sc1
  buffer_load_dwordx4 v[60:63], v6, s[16:19], s21 offen sc1
  s_waitcnt vmcnt(0)
  v_perm_b32 v9, v57, v56, s50
  v_perm_b32 v10, v59, v58, s54
  v_or_b32 v8, v9, v10
  v_xor_b32 v8, s31, v8
  v_perm_b32 v9, v61, v60, s50
  v_perm_b32 v10, v63, v62, s54
  v_or_b32 v9, v9, v10
  v_xor_b32 v9, s31, v9
  v_or_b32 v8, v8, v9
  v_cmp_ne_u32 vcc, 0, v8
  s_cbranch_vccz Lo_29
  s_mov_b64 exec, vcc
  s_add_u32 s6, s6, 1
  s_cmp_lt_u32 s6, 4000000
  s_cbranch_scc0 Lo_29
  s_sleep 2
  s_branch Lr_28
Lo_29:
  s_mov_b64 exec, -1
  v_and_or_b32 v56, v56, s30, v197
  v_and_or_b32 v57, v57, s30, v197
  v_and_or_b32 v58, v58, s30, v197
  v_and_or_b32 v59, v59, s30, v197
  v_and_or_b32 v60, v60, s30, v197
  v_and_or_b32 v61, v61, s30, v197
  v_and_or_b32 v62, v62, s30, v197
  v_and_or_b32 v63, v63, s30, v197
  v_pk_add_f32 v[56:57], v[56:57], v[60:61]
  v_pk_add_f32 v[58:59], v[58:59], v[62:63]
  v_mov_b32 v60, v56
  v_mov_b32 v61, v57
  v_mov_b32 v62, v58
  v_mov_b32 v63, v59
  s_nop 1
  v_permlane32_swap_b32 v56, v60
  v_permlane32_swap_b32 v57, v61
  v_permlane32_swap_b32 v58, v62
  v_permlane32_swap_b32 v59, v63
  v_pk_add_f32 v[56:57], v[56:57], v[60:61]
  v_pk_add_f32 v[58:59], v[58:59], v[62:63]
  v_cvt_pk_bf16_f32 v56, v56, v57
  v_cvt_pk_bf16_f32 v57, v58, v59
  s_mov_b32 exec_hi, 0
  ds_write_b64 v7, v[56:57]
  s_mov_b64 exec, -1
  s_waitcnt lgkmcnt(0)
  s_mov_b64 exec, 1
  ds_add_u32 v2, v3 offset:16
  s_mov_b64 exec, -1
  v_add_u32 v6, s63, v149
  s_cmp_lg_u32 s7, 3
  s_cbranch_scc1 L3_30
  s_lshr_b32 s20, s49, 3
  s_lshl_b32 s21, s20, 16
  s_and_b32 s22, s49, 7
  s_lshl_b32 s22, s22, 7
  s_add_u32 s21, s21, s22
  s_mov_b32 m0, 157440
  s_nop 0
  buffer_load_dwordx4 v148, s[36:39], s21 offen nt lds
  s_mov_b32 m0, 158464
  s_add_u32 s21, s21, 8192
  buffer_load_dwordx4 v148, s[36:39], s21 offen nt lds
  s_mov_b32 m0, 159488
  s_add_u32 s21, s21, 8192
  buffer_load_dwordx4 v148, s[36:39], s21 offen nt lds
  s_mov_b32 m0, 160512
  s_add_u32 s21, s21, 8192
  buffer_load_dwordx4 v148, s[36:39], s21 offen nt lds
L3_30:
  ds_read_b64_tr_b16 v[120:121], v6 offset:0
  ds_read_b64_tr_b16 v[122:123], v6 offset:512
  ds_read_b64_tr_b16 v[124:125], v6 offset:32
  ds_read_b64_tr_b16 v[126:127], v6 offset:544
  ds_read_b64_tr_b16 v[128:129], v6 offset:64
  ds_read_b64_tr_b16 v[130:131], v6 offset:576
  ds_read_b64_tr_b16 v[132:133], v6 offset:96
  ds_read_b64_tr_b16 v[134:135], v6 offset:608
  s_waitcnt lgkmcnt(0)
  s_cmp_lg_u32 s7, 3
  s_cbranch_scc1 L4_31
  s_add_u32 m0, s63, 0
  s_add_u32 s21, s21, 8192
  buffer_load_dwordx4 v148, s[36:39], s21 offen nt lds
  s_add_u32 m0, s63, 1024
  s_add_u32 s21, s21, 8192
  buffer_load_dwordx4 v148, s[36:39], s21 offen nt lds
  s_add_u32 m0, s63, 2048
  s_add_u32 s21, s21, 8192
  buffer_load_dwordx4 v148, s[36:39], s21 offen nt lds
  s_add_u32 m0, s63, 3072
  s_add_u32 s21, s21, 8192
  buffer_load_dwordx4 v148, s[36:39], s21 offen nt lds
  v_add_u32 v7, 157440, v149
  s_waitcnt vmcnt(4)
  ds_read_b64_tr_b16 v[160:161], v7 offset:0
  ds_read_b64_tr_b16 v[162:163], v7 offset:512
  ds_read_b64_tr_b16 v[168:169], v7 offset:32
  ds_read_b64_tr_b16 v[170:171], v7 offset:544
  ds_read_b64_tr_b16 v[176:177], v7 offset:64
  ds_read_b64_tr_b16 v[178:179], v7 offset:576
  ds_read_b64_tr_b16 v[184:185], v7 offset:96
  ds_read_b64_tr_b16 v[186:187], v7 offset:608
  s_waitcnt vmcnt(0)
  ds_read_b64_tr_b16 v[164:165], v6 offset:0
  ds_read_b64_tr_b16 v[166:167], v6 offset:512
  ds_read_b64_tr_b16 v[172:173], v6 offset:32
  ds_read_b64_tr_b16 v[174:175], v6 offset:544
  ds_read_b64_tr_b16 v[180:181], v6 offset:64
  ds_read_b64_tr_b16 v[182:183], v6 offset:576
  ds_read_b64_tr_b16 v[188:189], v6 offset:96
  ds_read_b64_tr_b16 v[190:191], v6 offset:608
  s_waitcnt lgkmcnt(0)
L4_31:
  s_lshl_b32 s53, s51, 5
  s_add_u32 s53, s53, s62
  v_and_b32 v6, 3, v0
  v_lshlrev_b32 v6, 3, v6
  s_lshl_b32 s20, s53, 5
  v_add_u32 v150, s20, v6
  v_lshl_add_u32 v150, v4, 1, v150
  s_cmp_eq_u32 s7, 1
  s_cbranch_scc1 L_ffn
  s_cmp_eq_u32 s7, 2
  s_cbranch_scc1 L_stats
  s_cmp_eq_u32 s7, 0
  s_cbranch_scc1 L_fin_prep
  s_branch L_down
L_ffn:
  s_mov_b32 s66, 256
  s_mov_b32 s67, 0x20000
  s_lshl_b32 s20, s4, 5
  v_mov_b32 v6, s20
  s_waitcnt vmcnt(0)
  s_mov_b32 s6, 0
  s_mov_b64 exec, 1
Lr_32:
  buffer_load_dwordx2 v[56:57], v6, s[64:67], 0 offen sc1
  s_waitcnt vmcnt(0)
  v_readfirstlane_b32 s22, v56
  v_readfirstlane_b32 s23, v57
  s_and_b32 s24, s22, 0x00ff00ff
  s_lshr_b32 s25, s22, 8
  s_and_b32 s25, s25, 0x00ff00ff
  s_add_u32 s24, s24, s25
  s_and_b32 s25, s23, 0x00ff00ff
  s_add_u32 s24, s24, s25
  s_lshr_b32 s25, s23, 8
  s_and_b32 s25, s25, 0x00ff00ff
  s_add_u32 s24, s24, s25
  s_lshr_b32 s25, s24, 16
  s_and_b32 s24, s24, 0xffff
  s_add_u32 s24, s24, s25
  s_cmp_ge_u32 s24, 32
  s_cbranch_scc1 Lo_33
  s_add_u32 s6, s6, 1
  s_cmp_lt_u32 s6, 4000000
  s_cbranch_scc0 Lo_33
  s_sleep 32
  s_branch Lr_32
Lo_33:
  s_mov_b64 exec, -1
  s_getreg_b32 s24, hwreg(HW_REG_XCC_ID, 0, 3)
  s_lshl_b32 s24, s24, 3
  s_lshr_b64 s[22:23], s[22:23], s24
  s_and_b32 s22, s22, 0xff
  s_cmp_eq_u32 s22, 32
  s_cselect_b32 s22, 2, 1
  v_mov_b32 v6, s22
  s_mov_b64 exec, 1
  ds_write_b32 v2, v6 offset:56
  s_mov_b64 exec, -1
  s_lshr_b32 s56, s22, 1
  s_cmp_eq_u32 s3, 0
  s_cbranch_scc1 L_ffn_done
  s_lshr_b32 s20, s49, 3
  v_mul_u32_u24 v6, 57344, v4
  v_lshl_add_u32 v6, v5, 4, v6
  s_lshl_b32 s21, s20, 11
  s_and_b32 s22, s49, 7
  s_lshl_b32 s22, s22, 8
  s_add_u32 s21, s21, s22
  s_add_u32 s21, s21, 524288
  s_add_u32 s22, s21, 229376
  s_mov_b32 s6, 0
Lr_34:
  buffer_load_dwordx4 v[56:59], v6, s[16:19], s21 offen sc1
  buffer_load_dwordx4 v[60:63], v6, s[16:19], s22 offen sc1
  s_waitcnt vmcnt(0)
  v_perm_b32 v9, v57, v56, s50
  v_perm_b32 v10, v59, v58, s54
  v_or_b32 v8, v9, v10
  v_xor_b32 v8, s31, v8
  v_perm_b32 v9, v61, v60, s50
  v_perm_b32 v10, v63, v62, s54
  v_or_b32 v9, v9, v10
  v_xor_b32 v9, s31, v9
  v_or_b32 v8, v8, v9
  v_cmp_ne_u32 vcc, 0, v8
  s_cbranch_vccz Lo_35
  s_mov_b64 exec, vcc
  s_add_u32 s6, s6, 1
  s_cmp_lt_u32 s6, 4000000
  s_cbranch_scc0 Lo_35
  s_sleep 24
  s_branch Lr_34
Lo_35:
  s_mov_b64 exec, -1
  v_and_or_b32 v56, v56, s30, v197
  v_and_or_b32 v57, v57, s30, v197
  v_and_or_b32 v58, v58, s30, v197
  v_and_or_b32 v59, v59, s30, v197
  v_and_or_b32 v60, v60, s30, v197
  v_and_or_b32 v61, v61, s30, v197
  v_and_or_b32 v62, v62, s30, v197
  v_and_or_b32 v63, v63, s30, v197
  v_mov_b32 v64, v56
  v_mov_b32 v65, v57
  v_mov_b32 v66, v58
  v_mov_b32 v67, v59
  v_mov_b32 v68, v60
  v_mov_b32 v69, v61
  v_mov_b32 v70, v62
  v_mov_b32 v71, v63
  s_nop 1
  v_permlane16_swap_b32 v56, v64
  v_permlane16_swap_b32 v57, v65
  v_permlane16_swap_b32 v58, v66
  v_permlane16_swap_b32 v59, v67
  v_permlane16_swap_b32 v60, v68
  v_permlane16_swap_b32 v61, v69
  v_permlane16_swap_b32 v62, v70
  v_permlane16_swap_b32 v63, v71
  v_pk_add_f32 v[56:57], v[56:57], v[64:65]
  v_pk_add_f32 v[58:59], v[58:59], v[66:67]
  v_pk_add_f32 v[60:61], v[60:61], v[68:69]
  v_pk_add_f32 v[62:63], v[62:63], v[70:71]
  v_mov_b32 v64, v56
  v_mov_b32 v65, v57
  v_mov_b32 v66, v58
  v_mov_b32 v67, v59
  v_mov_b32 v68, v60
  v_mov_b32 v69, v61
  v_mov_b32 v70, v62
  v_mov_b32 v71, v63
  s_nop 1
  v_permlane32_swap_b32 v56, v64
  v_permlane32_swap_b32 v57, v65
  v_permlane32_swap_b32 v58, v66
  v_permlane32_swap_b32 v59, v67
  v_permlane32_swap_b32 v60, v68
  v_permlane32_swap_b32 v61, v69
  v_permlane32_swap_b32 v62, v70
  v_permlane32_swap_b32 v63, v71
  v_pk_add_f32 v[56:57], v[56:57], v[64:65]
  v_pk_add_f32 v[58:59], v[58:59], v[66:67]
  v_pk_add_f32 v[60:61], v[60:61], v[68:69]
  v_pk_add_f32 v[62:63], v[62:63], v[70:71]
  v_cvt_pk_bf16_f32 v56, v56, v56
  v_and_b32 v56, s48, v56
  v_cvt_pk_bf16_f32 v57, v57, v57
  v_and_b32 v57, s48, v57
  v_cvt_pk_bf16_f32 v58, v58, v58
  v_and_b32 v58, s48, v58
  v_cvt_pk_bf16_f32 v59, v59, v59
  v_and_b32 v59, s48, v59
  v_cvt_pk_bf16_f32 v60, v60, v60
  v_and_b32 v60, s48, v60
  v_cvt_pk_bf16_f32 v61, v61, v61
  v_and_b32 v61, s48, v61
  v_cvt_pk_bf16_f32 v62, v62, v62
  v_and_b32 v62, s48, v62
  v_cvt_pk_bf16_f32 v63, v63, v63
  v_and_b32 v63, s48, v63
  s_mov_b32 s22, 0xBFB8AA3B
  v_mul_f32 v56, s22, v56
  v_mul_f32 v57, s22, v57
  v_mul_f32 v58, s22, v58
  v_mul_f32 v59, s22, v59
  v_exp_f32 v56, v56
  v_exp_f32 v57, v57
  v_exp_f32 v58, v58
  v_exp_f32 v59, v59
  s_nop 0
  v_add_f32 v56, 1.0, v56
  v_add_f32 v57, 1.0, v57
  v_add_f32 v58, 1.0, v58
  v_add_f32 v59, 1.0, v59
  v_rcp_f32 v56, v56
  v_rcp_f32 v57, v57
  v_rcp_f32 v58, v58
  v_rcp_f32 v59, v59
  s_nop 0
  v_cvt_pk_bf16_f32 v56, v56, v56
  v_and_b32 v56, s48, v56
  v_cvt_pk_bf16_f32 v57, v57, v57
  v_and_b32 v57, s48, v57
  v_cvt_pk_bf16_f32 v58, v58, v58
  v_and_b32 v58, s48, v58
  v_cvt_pk_bf16_f32 v59, v59, v59
  v_and_b32 v59, s48, v59
  v_mul_f32 v56, v56, v60
  v_mul_f32 v57, v57, v61
  v_mul_f32 v58, v58, v62
  v_mul_f32 v59, v59, v63
  v_cvt_pk_bf16_f32 v56, v56, v56
  v_and_b32 v56, s48, v56
  v_cvt_pk_bf16_f32 v57, v57, v57
  v_and_b32 v57, s48, v57
  v_cvt_pk_bf16_f32 v58, v58, v58
  v_and_b32 v58, s48, v58
  v_cvt_pk_bf16_f32 v59, v59, v59
  v_and_b32 v59, s48, v59
  v_or_b32 v56, v56, v156
  v_or_b32 v57, v57, v156
  v_or_b32 v58, v58, v156
  v_or_b32 v59, v59, v156
  v_lshlrev_b32 v6, 4, v0
  s_lshl_b32 s21, s49, 8
  s_add_u32 s21, s21, 983040
  s_mov_b64 exec, 0xffff
  s_cmp_eq_u32 s56, 0
  s_cbranch_scc1 Lsl_36
  buffer_store_dwordx4 v[56:59], v6, s[16:19], s21 offen
  s_branch Lsl_37
Lsl_36:
  buffer_store_dwordx4 v[56:59], v6, s[16:19], s21 offen sc1
Lsl_37:
  s_mov_b64 exec, -1
L_ffn_done:
  s_mov_b64 exec, 1
  ds_add_u32 v2, v3 offset:40
  s_mov_b64 exec, -1
  s_mov_b32 s6, 0
Lw_38:
  ds_read_b32 v11, v2 offset:52
  s_waitcnt lgkmcnt(0)
  v_readfirstlane_b32 s27, v11
  s_cmp_ge_u32 s27, 1
  s_cbranch_scc1 Lwd_39
  s_add_u32 s6, s6, 1
  s_cmp_lt_u32 s6, 4000000
  s_cbranch_scc0 Lwd_39
  s_sleep 4
  s_branch Lw_38
Lwd_39:
  v_mov_b32 v56, v156
  v_mov_b32 v57, v156
  v_mov_b32 v58, v156
  v_mov_b32 v59, v156
  s_lshl_b32 s20, s4, 9
  s_lshl_b32 s21, s5, 4
  s_add_u32 s20, s20, s21
  s_add_u32 s20, s20, 2752512
  v_mov_b32 v6, 0
  s_mov_b64 exec, 1
  s_cmp_eq_u32 s56, 0
  s_cbranch_scc1 Lsl_40
  buffer_store_dwordx4 v[56:59], v6, s[16:19], s20 offen
  s_branch Lsl_41
Lsl_40:
  buffer_store_dwordx4 v[56:59], v6, s[16:19], s20 offen sc1
Lsl_41:
  s_mov_b64 exec, -1
  s_branch L_B1
L_down:
  s_cmp_eq_u32 s3, 0
  s_cbranch_scc1 L_down_done
  s_mov_b32 s6, 0
Lw_42:
  ds_read_b32 v11, v2 offset:40
  s_waitcnt lgkmcnt(0)
  v_readfirstlane_b32 s27, v11
  s_cmp_ge_u32 s27, 1
  s_cbranch_scc1 Lwd_43
  s_add_u32 s6, s6, 1
  s_cmp_lt_u32 s6, 4000000
  s_cbranch_scc0 Lwd_43
  s_sleep 8
  s_branch Lw_42
Lwd_43:
  s_lshr_b32 s20, s49, 3
  v_and_b32 v6, 7, v5
  v_lshlrev_b32 v6, 8, v6
  v_lshl_add_u32 v6, v4, 5, v6
  s_lshl_b32 s21, s20, 11
  s_add_u32 s21, s21, 983040
  s_mov_b32 s6, 0
Lr_44:
  buffer_load_dwordx4 v[56:59], v6, s[16:19], s21 offen offset:0 sc1
  buffer_load_dwordx4 v[60:63], v6, s[16:19], s21 offen offset:16 sc1
  buffer_load_dwordx4 v[64:67], v6, s[16:19], s21 offen offset:128 sc1
  buffer_load_dwordx4 v[68:71], v6, s[16:19], s21 offen offset:144 sc1
  s_waitcnt vmcnt(0)
  v_perm_b32 v9, v57, v56, s50
  v_perm_b32 v10, v59, v58, s54
  v_or_b32 v8, v9, v10
  v_xor_b32 v8, s31, v8
  v_perm_b32 v9, v61, v60, s50
  v_perm_b32 v10, v63, v62, s54
  v_or_b32 v9, v9, v10
  v_xor_b32 v9, s31, v9
  v_or_b32 v8, v8, v9
  v_perm_b32 v9, v65, v64, s50
  v_perm_b32 v10, v67, v66, s54
  v_or_b32 v9, v9, v10
  v_xor_b32 v9, s31, v9
  v_or_b32 v8, v8, v9
  v_perm_b32 v9, v69, v68, s50
  v_perm_b32 v10, v71, v70, s54
  v_or_b32 v9, v9, v10
  v_xor_b32 v9, s31, v9
  v_or_b32 v8, v8, v9
  v_cmp_ne_u32 vcc, 0, v8
  s_cbranch_vccz Lo_45
  s_mov_b64 exec, vcc
  s_add_u32 s6, s6, 1
  s_cmp_lt_u32 s6, 4000000
  s_cbranch_scc0 Lo_45
  s_sleep 24
  s_branch Lr_44
Lo_45:
  s_mov_b64 exec, -1
  s_mov_b32 s22, 0x07060302
  v_perm_b32 v72, v57, v56, s22
  v_perm_b32 v73, v59, v58, s22
  v_perm_b32 v74, v61, v60, s22
  v_perm_b32 v75, v63, v62, s22
  v_perm_b32 v76, v65, v64, s22
  v_perm_b32 v77, v67, v66, s22
  v_perm_b32 v78, v69, v68, s22
  v_perm_b32 v79, v71, v70, s22
  s_nop 1
  v_mfma_f32_16x16x32_bf16 v[88:91], v[160:163], v[72:75], 0
  v_mfma_f32_16x16x32_bf16 v[88:91], v[164:167], v[76:79], v[88:91]
  v_mfma_f32_16x16x32_bf16 v[92:95], v[168:171], v[72:75], 0
  v_mfma_f32_16x16x32_bf16 v[92:95], v[172:175], v[76:79], v[92:95]
  v_mfma_f32_16x16x32_bf16 v[96:99], v[176:179], v[72:75], 0
  v_mfma_f32_16x16x32_bf16 v[96:99], v[180:183], v[76:79], v[96:99]
  v_mfma_f32_16x16x32_bf16 v[100:103], v[184:187], v[72:75], 0
  v_mfma_f32_16x16x32_bf16 v[100:103], v[188:191], v[76:79], v[100:103]
  v_lshlrev_b32 v6, 16, v5
  v_lshl_add_u32 v6, v4, 4, v6
  s_and_b32 s21, s49, 7
  s_lshl_b32 s21, s21, 13
  s_lshl_b32 s22, s20, 6
  s_add_u32 s21, s21, s22
  s_add_u32 s21, s21, 1638400
  s_nop 7
  v_and_or_b32 v88, v88, s30, v156
  v_and_or_b32 v89, v89, s30, v156
  v_and_or_b32 v90, v90, s30, v156
  v_and_or_b32 v91, v91, s30, v156
  v_and_or_b32 v92, v92, s30, v156
  v_and_or_b32 v93, v93, s30, v156
  v_and_or_b32 v94, v94, s30, v156
  v_and_or_b32 v95, v95, s30, v156
  v_and_or_b32 v96, v96, s30, v156
  v_and_or_b32 v97, v97, s30, v156
  v_and_or_b32 v98, v98, s30, v156
  v_and_or_b32 v99, v99, s30, v156
  v_and_or_b32 v100, v100, s30, v156
  v_and_or_b32 v101, v101, s30, v156
  v_and_or_b32 v102, v102, s30, v156
  v_and_or_b32 v103, v103, s30, v156
  s_mov_b64 exec, s[60:61]
  buffer_store_dwordx4 v[88:91], v6, s[16:19], s21 offen sc1
  s_add_u32 s21, s21, 2048
  buffer_store_dwordx4 v[92:95], v6, s[16:19], s21 offen sc1
  s_add_u32 s21, s21, 2048
  buffer_store_dwordx4 v[96:99], v6, s[16:19], s21 offen sc1
  s_add_u32 s21, s21, 2048
  buffer_store_dwordx4 v[100:103], v6, s[16:19], s21 offen sc1
  s_mov_b64 exec, -1
  s_waitcnt vmcnt(0)
L_down_done:
  s_mov_b64 exec, 1
  ds_add_u32 v2, v3 offset:44
  s_mov_b64 exec, -1
  s_branch L_B1
L_stats:
  s_mov_b32 s6, 0
Lw_46:
  ds_read_b32 v11, v2 offset:24
  s_waitcnt lgkmcnt(0)
  v_readfirstlane_b32 s27, v11
  s_cmp_ge_u32 s27, 4
  s_cbranch_scc1 Lwd_47
  s_add_u32 s6, s6, 1
  s_cmp_lt_u32 s6, 4000000
  s_cbranch_scc0 Lwd_47
  s_sleep 4
  s_branch Lw_46
Lwd_47:
  v_lshl_add_u32 v6, v5, 3, v2
  ds_read_b64 v[56:57], v6 offset:64
  s_waitcnt lgkmcnt(0)
  v_mov_b32 v60, v56
  s_nop 1
  v_max_f32_dpp v60, v60, v60 row_ror:4 row_mask:0xf bank_mask:0xf
  s_nop 1
  v_max_f32_dpp v60, v60, v60 row_ror:8 row_mask:0xf bank_mask:0xf
  s_mov_b32 s22, 0x3FB8AA3B
  v_sub_f32 v58, v56, v60
  v_mul_f32 v58, s22, v58
  v_exp_f32 v58, v58
  s_nop 0
  v_mul_f32 v61, v57, v58
  s_nop 1
  v_add_f32_dpp v61, v61, v61 row_ror:4 row_mask:0xf bank_mask:0xf
  s_nop 1
  v_add_f32_dpp v61, v61, v61 row_ror:8 row_mask:0xf bank_mask:0xf
  s_nop 1
  v_mov_b32_dpp v62, v60 row_shl:1 row_mask:0xf bank_mask:0xf bound_ctrl:0
  v_mov_b32_dpp v63, v61 row_shl:1 row_mask:0xf bank_mask:0xf bound_ctrl:0
  s_lshl_b32 s20, s51, 3
  s_add_u32 s20, s20, s4
  s_lshl_b32 s20, s20, 7
  s_add_u32 s20, s20, 1572864
  s_lshl_b32 s21, s52, 5
  s_add_u32 s21, s21, s20
  v_and_or_b32 v60, v60, s30, v156
  v_and_or_b32 v61, v61, s30, v156
  v_and_or_b32 v62, v62, s30, v156
  v_and_or_b32 v63, v63, s30, v156
  v_lshlrev_b32 v7, 3, v5
  s_mov_b32 s6, 0
Lw_48:
  ds_read_b32 v11, v2 offset:56
  s_waitcnt lgkmcnt(0)
  v_readfirstlane_b32 s27, v11
  s_cmp_ge_u32 s27, 1
  s_cbranch_scc1 Lwd_49
  s_add_u32 s6, s6, 1
  s_cmp_lt_u32 s6, 4000000
  s_cbranch_scc0 Lwd_49
  s_sleep 1
  s_branch Lw_48
Lwd_49:
  s_lshr_b32 s56, s27, 1
  s_mov_b64 exec, 5
  s_cmp_eq_u32 s56, 0
  s_cbranch_scc1 Lsl_50
  buffer_store_dwordx4 v[60:63], v7, s[16:19], s21 offen
  s_branch Lsl_51
Lsl_50:
  buffer_store_dwordx4 v[60:63], v7, s[16:19], s21 offen sc1
Lsl_51:
  s_mov_b64 exec, -1
  v_lshrrev_b32 v7, 1, v5
  v_lshlrev_b32 v7, 4, v7
  s_mov_b32 s6, 0
Lr_52:
  buffer_load_dwordx4 v[64:67], v7, s[16:19], s20 offen sc1
  s_waitcnt vmcnt(0)
  v_perm_b32 v9, v65, v64, s50
  v_perm_b32 v10, v67, v66, s54
  v_or_b32 v8, v9, v10
  v_xor_b32 v8, s31, v8
  v_cmp_ne_u32 vcc, 0, v8
  s_cbranch_vccz Lo_53
  s_mov_b64 exec, vcc
  s_add_u32 s6, s6, 1
  s_cmp_lt_u32 s6, 4000000
  s_cbranch_scc0 Lo_53
  s_sleep 24
  s_branch Lr_52
Lo_53:
  s_mov_b64 exec, -1
  v_and_b32 v8, 1, v5
  v_cmp_eq_u32 vcc, 1, v8
  s_nop 1
  v_cndmask_b32 v64, v64, v66, vcc
  v_cndmask_b32 v65, v65, v67, vcc
  v_and_b32 v64, s30, v64
  v_and_or_b32 v65, v65, s30, v197
  v_mov_b32 v68, v64
  s_nop 1
  v_max_f32_dpp v68, v68, v68 row_ror:4 row_mask:0xf bank_mask:0xf
  s_nop 1
  v_max_f32_dpp v68, v68, v68 row_ror:8 row_mask:0xf bank_mask:0xf
  v_sub_f32 v58, v64, v68
  v_mul_f32 v58, s22, v58
  v_exp_f32 v58, v58
  s_nop 0
  v_mul_f32 v69, v65, v58
  s_nop 1
  v_add_f32_dpp v69, v69, v69 row_ror:4 row_mask:0xf bank_mask:0xf
  s_nop 1
  v_add_f32_dpp v69, v69, v69 row_ror:8 row_mask:0xf bank_mask:0xf
  v_sub_f32 v58, v56, v68
  v_mul_f32 v58, s22, v58
  v_exp_f32 v58, v58
  v_rcp_f32 v69, v69
  s_nop 0
  v_mul_f32 v58, v58, v69
  v_and_b32 v6, 3, v5
  v_lshlrev_b32 v6, 4, v6
  v_lshrrev_b32 v7, 2, v5
  v_lshl_add_u32 v6, v7, 2, v6
  v_add_u32 v6, v6, v2
  s_mov_b64 exec, 0xffff
  ds_write_b32 v6, v58 offset:192
  s_mov_b64 exec, -1
  s_waitcnt lgkmcnt(0)
  s_mov_b64 exec, 1
  ds_add_u32 v2, v3 offset:12
  s_mov_b64 exec, -1
  s_branch L_B1
L_fin_prep:
  s_mov_b32 s6, 0
Lw_54:
  ds_read_b32 v11, v2 offset:48
  s_waitcnt lgkmcnt(0)
  v_readfirstlane_b32 s27, v11
  s_cmp_ge_u32 s27, 1
  s_cbranch_scc1 Lwd_55
  s_add_u32 s6, s6, 1
  s_cmp_lt_u32 s6, 4000000
  s_cbranch_scc0 Lwd_55
  s_sleep 8
  s_branch Lw_54
Lwd_55:
  buffer_load_ushort v64, v150, s[8:11], 0 offen
  v_lshlrev_b32 v6, 4, v0
  s_lshl_b32 s20, s53, 11
  s_add_u32 s20, s20, 1638400
  v_mov_b32 v60, v156
  v_mov_b32 v61, v156
  v_mov_b32 v62, v156
  v_mov_b32 v63, v156
  s_mov_b32 s6, 0
Lr_56:
  buffer_load_dwordx4 v[56:59], v6, s[16:19], s20 offen sc1
  s_mov_b64 s[24:25], exec
  s_and_b32 exec_hi, exec_hi, 0xffff
  s_cbranch_execz Ls_58
  buffer_load_dwordx4 v[60:63], v6, s[16:19], s20 offen offset:1024 sc1
Ls_58:
  s_mov_b64 exec, s[24:25]
  s_waitcnt vmcnt(0)
  v_perm_b32 v9, v57, v56, s50
  v_perm_b32 v10, v59, v58, s54
  v_or_b32 v8, v9, v10
  v_xor_b32 v8, s31, v8
  v_perm_b32 v9, v61, v60, s50
  v_perm_b32 v10, v63, v62, s54
  v_or_b32 v9, v9, v10
  v_xor_b32 v9, s31, v9
  v_or_b32 v8, v8, v9
  v_cmp_ne_u32 vcc, 0, v8
  s_cbranch_vccz Lo_57
  s_mov_b64 exec, vcc
  s_add_u32 s6, s6, 1
  s_cmp_lt_u32 s6, 4000000
  s_cbranch_scc0 Lo_57
  s_sleep 24
  s_branch Lr_56
Lo_57:
  s_mov_b64 exec, -1
  v_and_or_b32 v56, v56, s30, v197
  v_and_or_b32 v57, v57, s30, v197
  v_and_or_b32 v58, v58, s30, v197
  v_and_or_b32 v59, v59, s30, v197
  v_and_or_b32 v60, v60, s30, v197
  v_and_or_b32 v61, v61, s30, v197
  v_and_or_b32 v62, v62, s30, v197
  v_and_or_b32 v63, v63, s30, v197
  v_pk_add_f32 v[56:57], v[56:57], v[60:61]
  v_pk_add_f32 v[58:59], v[58:59], v[62:63]
  s_nop 1
  v_add_f32_dpp v56, v56, v56 row_ror:4 row_mask:0xf bank_mask:0xf
  v_add_f32_dpp v57, v57, v57 row_ror:4 row_mask:0xf bank_mask:0xf
  v_add_f32_dpp v58, v58, v58 row_ror:4 row_mask:0xf bank_mask:0xf
  v_add_f32_dpp v59, v59, v59 row_ror:4 row_mask:0xf bank_mask:0xf
  s_nop 1
  v_add_f32_dpp v56, v56, v56 row_ror:8 row_mask:0xf bank_mask:0xf
  v_add_f32_dpp v57, v57, v57 row_ror:8 row_mask:0xf bank_mask:0xf
  v_add_f32_dpp v58, v58, v58 row_ror:8 row_mask:0xf bank_mask:0xf
  v_add_f32_dpp v59, v59, v59 row_ror:8 row_mask:0xf bank_mask:0xf
  s_nop 0
  v_permlane16_swap_b32 v56, v57
  v_permlane16_swap_b32 v58, v59
  v_add_f32 v56, v56, v57
  v_add_f32 v58, v58, v59
  s_nop 1
  v_permlane32_swap_b32 v56, v58
  v_add_f32 v56, v56, v58
  v_cvt_pk_bf16_f32 v56, v56, v56
  v_and_b32 v56, s48, v56
  s_mov_b32 s22, 0xBFB8AA3B
  v_mul_f32 v60, s22, v56
  v_exp_f32 v60, v60
  s_nop 0
  v_add_f32 v60, 1.0, v60
  v_rcp_f32 v60, v60
  s_nop 0
  v_mul_f32 v140, v56, v60
  v_cvt_pk_bf16_f32 v140, v140, v140
  v_and_b32 v140, s48, v140
  v_lshlrev_b32 v136, 16, v64
L_B1:
  s_mov_b32 s6, 0
Lw_59:
  ds_read_b32 v11, v2 offset:56
  s_waitcnt lgkmcnt(0)
  v_readfirstlane_b32 s27, v11
  s_cmp_ge_u32 s27, 1
  s_cbranch_scc1 Lwd_60
  s_add_u32 s6, s6, 1
  s_cmp_lt_u32 s6, 4000000
  s_cbranch_scc0 Lwd_60
  s_sleep 8
  s_branch Lw_59
Lwd_60:
  s_lshr_b32 s56, s27, 1
  v_lshlrev_b32 v6, 7, v5
  v_lshl_add_u32 v6, v4, 5, v6
  s_lshl_b32 s20, s62, 14
  s_lshl_b32 s21, s7, 11
  s_add_u32 s20, s20, s21
  s_add_u32 s20, s20, 1048576
  s_add_u32 s21, s20, 8192
  v_lshlrev_b32 v7, 8, v4
  v_lshl_add_u32 v7, v5, 2, v7
  s_lshl_b32 s22, s7, 11
  s_add_u32 s22, s22, 131072
  v_add_u32 v7, s22, v7
  s_mov_b32 s55, 0x07060302
  s_sub_u32 s23, s7, 2
  s_lshl_b32 s24, s23, 10
  s_add_u32 s24, s24, 131072
  v_lshlrev_b32 v157, 8, v4
  v_lshl_add_u32 v157, v5, 4, v157
  v_add_u32 v157, s24, v157
  v_lshlrev_b32 v158, 16, v4
  v_lshrrev_b32 v8, 3, v5
  v_lshl_add_u32 v158, v8, 12, v158
  v_and_b32 v8, 7, v5
  v_lshl_add_u32 v158, v8, 4, v158
  s_lshl_b32 s23, s23, 18
  s_lshl_b32 s24, s51, 13
  s_add_u32 s23, s23, s24
  s_lshl_b32 s24, s62, 7
  s_add_u32 s23, s23, s24
  s_add_u32 s57, s23, 2162688
  v_lshrrev_b32 v159, 2, v0
  v_lshlrev_b32 v159, 7, v159
  v_and_b32 v8, 3, v0
  v_lshl_add_u32 v159, v8, 4, v159
  s_lshr_b32 s23, s53, 1
  s_lshl_b32 s23, s23, 12
  s_and_b32 s24, s53, 1
  s_lshl_b32 s24, s24, 6
  s_add_u32 s23, s23, s24
  s_add_u32 s58, s23, 2162688
  s_cmp_lg_u32 s7, 0
  s_cbranch_scc1 Lew_61
  v_lshlrev_b32 v11, 4, v0
  s_lshl_b32 s22, s4, 9
  s_add_u32 s22, s22, 2752512
  s_mov_b32 s6, 0
  s_mov_b32 exec_hi, 0
Lr_62:
  buffer_load_dwordx4 v[56:59], v11, s[16:19], s22 offen sc1
  s_waitcnt vmcnt(0)
  v_perm_b32 v9, v57, v56, s50
  v_perm_b32 v10, v59, v58, s54
  v_or_b32 v8, v9, v10
  v_xor_b32 v8, s31, v8
  v_cmp_ne_u32 vcc, 0, v8
  s_cbranch_vccz Lo_63
  s_mov_b64 exec, vcc
  s_add_u32 s6, s6, 1
  s_cmp_lt_u32 s6, 4000000
  s_cbranch_scc0 Lo_63
  s_cmp_eq_u32 s56, 0
  s_cbranch_scc0 Lz_64_l
  s_sleep 64
  s_branch Lr_62
Lz_64_l:
  s_sleep 8
  s_branch Lr_62
Lo_63:
  s_mov_b64 exec, -1
  s_mov_b64 exec, 1
  ds_add_u32 v2, v3 offset:28
  s_mov_b64 exec, -1
  s_branch Lew_65
Lew_61:
  s_mov_b32 s6, 0
Lw_66:
  ds_read_b32 v11, v2 offset:28
  s_waitcnt lgkmcnt(0)
  v_readfirstlane_b32 s27, v11
  s_cmp_ge_u32 s27, 1
  s_cbranch_scc1 Lwd_67
  s_add_u32 s6, s6, 1
  s_cmp_lt_u32 s6, 4000000
  s_cbranch_scc0 Lwd_67
  s_sleep 2
  s_branch Lw_66
Lwd_67:
Lew_65:
  s_mov_b32 s6, 0
  buffer_load_dwordx4 v[56:59], v6, s[16:19], s20 offen sc1
  buffer_load_dwordx4 v[60:63], v6, s[16:19], s20 offen offset:16 sc1
  buffer_load_dwordx4 v[64:67], v6, s[16:19], s21 offen sc1
  buffer_load_dwordx4 v[68:71], v6, s[16:19], s21 offen offset:16 sc1
  s_mov_b32 s6, 0
Lw_70:
  ds_read_b32 v11, v2 offset:4
  s_waitcnt lgkmcnt(0)
  v_readfirstlane_b32 s27, v11
  s_cmp_ge_u32 s27, 4
  s_cbranch_scc1 Lwd_71
  s_add_u32 s6, s6, 1
  s_cmp_lt_u32 s6, 4000000
  s_cbranch_scc0 Lwd_71
  s_sleep 1
  s_branch Lw_70
Lwd_71:
  s_mov_b32 s6, 0
  s_branch Lr_68_c
Lr_68:
  buffer_load_dwordx4 v[56:59], v6, s[16:19], s20 offen sc1
  buffer_load_dwordx4 v[60:63], v6, s[16:19], s20 offen offset:16 sc1
  buffer_load_dwordx4 v[64:67], v6, s[16:19], s21 offen sc1
  buffer_load_dwordx4 v[68:71], v6, s[16:19], s21 offen offset:16 sc1
Lr_68_c:
  s_waitcnt vmcnt(0)
  v_perm_b32 v9, v57, v56, s50
  v_perm_b32 v10, v59, v58, s54
  v_or_b32 v8, v9, v10
  v_xor_b32 v8, s31, v8
  v_perm_b32 v9, v61, v60, s50
  v_perm_b32 v10, v63, v62, s54
  v_or_b32 v9, v9, v10
  v_xor_b32 v9, s31, v9
  v_or_b32 v8, v8, v9
  v_perm_b32 v9, v65, v64, s50
  v_perm_b32 v10, v67, v66, s54
  v_or_b32 v9, v9, v10
  v_xor_b32 v9, s31, v9
  v_or_b32 v8, v8, v9
  v_perm_b32 v9, v69, v68, s50
  v_perm_b32 v10, v71, v70, s54
  v_or_b32 v9, v9, v10
  v_xor_b32 v9, s31, v9
  v_or_b32 v8, v8, v9
  v_cmp_ne_u32 vcc, 0, v8
  s_cbranch_vccz Lo_69
  s_mov_b64 exec, vcc
  s_add_u32 s6, s6, 1
  s_cmp_lt_u32 s6, 4000000
  s_cbranch_scc0 Lo_69
  s_cmp_eq_u32 s56, 0
  s_cbranch_scc0 Lz_72_l
  s_sleep 4
  s_branch Lr_68
Lz_72_l:
  s_branch Lr_68
Lo_69:
  s_mov_b64 exec, -1
  v_perm_b32 v72, v57, v56, s55
  v_perm_b32 v73, v59, v58, s55
  v_perm_b32 v74, v61, v60, s55
  v_perm_b32 v75, v63, v62, s55
  v_perm_b32 v76, v65, v64, s55
  v_perm_b32 v77, v67, v66, s55
  v_perm_b32 v78, v69, v68, s55
  v_perm_b32 v79, v71, v70, s55
  s_nop 1
  v_mfma_f32_16x16x32_bf16 v[88:91], v[72:75], v[120:123], 0
  v_mfma_f32_16x16x32_bf16 v[92:95], v[72:75], v[124:127], 0
  v_mfma_f32_16x16x32_bf16 v[96:99], v[72:75], v[128:131], 0
  v_mfma_f32_16x16x32_bf16 v[100:103], v[72:75], v[132:135], 0
  v_mfma_f32_16x16x32_bf16 v[104:107], v[76:79], v[120:123], 0
  v_mfma_f32_16x16x32_bf16 v[108:111], v[76:79], v[124:127], 0
  v_mfma_f32_16x16x32_bf16 v[112:115], v[76:79], v[128:131], 0
  v_mfma_f32_16x16x32_bf16 v[116:119], v[76:79], v[132:135], 0
  s_nop 0
  v_pk_add_f32 v[88:89], v[88:89], v[90:91]
  v_add_f32 v88, v88, v89
  v_pk_add_f32 v[92:93], v[92:93], v[94:95]
  v_add_f32 v92, v92, v93
  v_pk_add_f32 v[96:97], v[96:97], v[98:99]
  v_add_f32 v96, v96, v97
  v_pk_add_f32 v[100:101], v[100:101], v[102:103]
  v_add_f32 v100, v100, v101
  v_pk_add_f32 v[104:105], v[104:105], v[106:107]
  v_add_f32 v104, v104, v105
  v_pk_add_f32 v[108:109], v[108:109], v[110:111]
  v_add_f32 v108, v108, v109
  v_pk_add_f32 v[112:113], v[112:113], v[114:115]
  v_add_f32 v112, v112, v113
  v_pk_add_f32 v[116:117], v[116:117], v[118:119]
  v_add_f32 v116, v116, v117
  ds_write_b32 v7, v88 offset:0
  ds_write_b32 v7, v92 offset:64
  ds_write_b32 v7, v96 offset:128
  ds_write_b32 v7, v100 offset:192
  ds_write_b32 v7, v104 offset:1024
  ds_write_b32 v7, v108 offset:1088
  ds_write_b32 v7, v112 offset:1152
  ds_write_b32 v7, v116 offset:1216
  s_waitcnt lgkmcnt(0)
  s_barrier
  s_cmp_eq_u32 s7, 0
  s_cbranch_scc1 L_hop2
  s_cmp_eq_u32 s7, 1
  s_cbranch_scc1 L_H_done
  ds_read_b128 v[56:59], v157 offset:0
  ds_read_b128 v[60:63], v157 offset:2048
  ds_read_b128 v[64:67], v157 offset:4096
  ds_read_b128 v[68:71], v157 offset:6144
  s_waitcnt lgkmcnt(2)
  v_pk_add_f32 v[56:57], v[56:57], v[60:61]
  v_pk_add_f32 v[58:59], v[58:59], v[62:63]
  s_waitcnt lgkmcnt(0)
  v_pk_add_f32 v[64:65], v[64:65], v[68:69]
  v_pk_add_f32 v[66:67], v[66:67], v[70:71]
  v_pk_add_f32 v[56:57], v[56:57], v[64:65]
  v_pk_add_f32 v[58:59], v[58:59], v[66:67]
  v_and_or_b32 v56, v56, s30, v156
  v_and_or_b32 v57, v57, s30, v156
  v_and_or_b32 v58, v58, s30, v156
  v_and_or_b32 v59, v59, s30, v156
  buffer_store_dwordx4 v[56:59], v158, s[16:19], s57 offen sc1
  s_endpgm
L_hop2:
  s_mov_b32 s6, 0
Lr_73:
  buffer_load_dwordx4 v[56:59], v159, s[16:19], s58 offen sc1
  buffer_load_dwordx4 v[60:63], v159, s[16:19], s58 offen offset:2048 sc1
  s_waitcnt vmcnt(0)
  v_perm_b32 v9, v57, v56, s50
  v_perm_b32 v10, v59, v58, s54
  v_or_b32 v8, v9, v10
  v_xor_b32 v8, s31, v8
  v_perm_b32 v9, v61, v60, s50
  v_perm_b32 v10, v63, v62, s54
  v_or_b32 v9, v9, v10
  v_xor_b32 v9, s31, v9
  v_or_b32 v8, v8, v9
  v_cmp_ne_u32 vcc, 0, v8
  s_cbranch_vccz Lo_74
  s_mov_b64 exec, vcc
  s_add_u32 s6, s6, 1
  s_cmp_lt_u32 s6, 4000000
  s_cbranch_scc0 Lo_74
  s_sleep 0
  s_branch Lr_73
Lo_74:
  s_mov_b64 exec, -1
  v_and_or_b32 v56, v56, s30, v197
  v_and_or_b32 v57, v57, s30, v197
  v_and_or_b32 v58, v58, s30, v197
  v_and_or_b32 v59, v59, s30, v197
  v_and_or_b32 v60, v60, s30, v197
  v_and_or_b32 v61, v61, s30, v197
  v_and_or_b32 v62, v62, s30, v197
  v_and_or_b32 v63, v63, s30, v197
  v_pk_add_f32 v[56:57], v[56:57], v[60:61]
  v_pk_add_f32 v[58:59], v[58:59], v[62:63]
  s_nop 1
  v_add_f32_dpp v56, v56, v56 row_ror:4 row_mask:0xf bank_mask:0xf
  v_add_f32_dpp v57, v57, v57 row_ror:4 row_mask:0xf bank_mask:0xf
  v_add_f32_dpp v58, v58, v58 row_ror:4 row_mask:0xf bank_mask:0xf
  v_add_f32_dpp v59, v59, v59 row_ror:4 row_mask:0xf bank_mask:0xf
  s_nop 1
  v_add_f32_dpp v56, v56, v56 row_ror:8 row_mask:0xf bank_mask:0xf
  v_add_f32_dpp v57, v57, v57 row_ror:8 row_mask:0xf bank_mask:0xf
  v_add_f32_dpp v58, v58, v58 row_ror:8 row_mask:0xf bank_mask:0xf
  v_add_f32_dpp v59, v59, v59 row_ror:8 row_mask:0xf bank_mask:0xf
  s_nop 0
  v_permlane16_swap_b32 v56, v57
  v_permlane16_swap_b32 v58, v59
  v_add_f32 v56, v56, v57
  v_add_f32 v58, v58, v59
  s_nop 1
  v_permlane32_swap_b32 v56, v58
  v_add_f32 v56, v56, v58
  v_cvt_pk_bf16_f32 v56, v56, v56
  v_and_b32 v56, s48, v56
  v_mul_f32 v56, v56, v140
  v_cvt_pk_bf16_f32 v56, v56, v56
  v_and_b32 v56, s48, v56
  v_add_f32 v56, v56, v136
  v_cvt_pk_bf16_f32 v56, v56, v56
  s_mov_b32 exec_lo, 0x000f000f
  s_mov_b32 exec_hi, 0x000f000f
  buffer_store_short v56, v150, s[44:47], 0 offen
  s_mov_b64 exec, -1
  s_cmp_lg_u32 s2, 0
  s_cbranch_scc1 Le_75
  s_add_u32 s20, s28, 1
  v_mov_b32 v88, s20
  v_mov_b32 v6, 1044480
  s_mov_b64 exec, 1
  buffer_store_dword v88, v6, s[16:19], 0 offen
  s_mov_b64 exec, -1
Le_75:
L_tsdump:
  s_waitcnt vmcnt(0)
L_H_done:
L_end:
  s_endpgm
L_code_end:

.section .rodata,"a"
.p2align 6
.amdhsa_kernel recurrent_scan__gqa_block_cached__glu_gated_glu__decode_kernel
  .amdhsa_next_free_vgpr 200
  .amdhsa_next_free_sgpr 102
  .amdhsa_accum_offset 200
  .amdhsa_group_segment_fixed_size 0
  .amdhsa_kernarg_size 96
  .amdhsa_user_sgpr_count 2
  .amdhsa_user_sgpr_kernarg_segment_ptr 1
  .amdhsa_system_sgpr_workgroup_id_x 1
.end_amdhsa_kernel
```
